```python
import torch

def _softmax(x, axis=-1):
    return torch.softmax(x, dim=axis)
def _gelu(x):
    return torch.nn.functional.gelu(x, approximate="tanh")
def _silu(x):
    return torch.nn.functional.silu(x)
def _sigmoid(x):
    return torch.sigmoid(x)
def _layernorm(x, axis=-1, eps=1e-5):
    m = x.mean(dim=axis, keepdim=True)
    v = x.var(dim=axis, keepdim=True, unbiased=False)
    return (x - m) / torch.sqrt(v + eps)
def _scatter_add(tgt, idx, src, axis=0):
    return tgt.clone().index_add_(axis, idx, src)
def _segment_sum(src, seg, n):
    out = torch.zeros((n,) + src.shape[1:], dtype=src.dtype)
    return out.index_add_(0, seg, src)
def _pad(x, pw):
    flat = tuple(v for pair in reversed(pw) for v in pair)
    return torch.nn.functional.pad(x, flat)

kernel_name = 'concat_heads__mha_block_cached__mha_block_cached__near_ridge'

def setup_inputs():

    _w = (lambda a: (lambda t: t.to(torch.bfloat16) if t.is_floating_point() else t)(torch.as_tensor(a)))
    def _A_setup():
        B, Sq, D = 16, 80, 512
        H, Sk, Dh = 32, 80, 128
        return {
            "x": _w((lambda *s: torch.randn(*s, dtype=torch.bfloat16) * 0.8)(B, Sq, D)),
            "k_cache": _w((lambda *s: torch.randn(*s, dtype=torch.bfloat16) * 0.8)(B, H, Sk, Dh)),
            "v_cache": _w((lambda *s: torch.randn(*s, dtype=torch.bfloat16) * 0.05)(B, H, Sk, Dh)),
            "wq": _w((lambda *s: torch.randn(*s, dtype=torch.bfloat16) * 0.8)(D, H * Dh) * (D ** -0.5)),
            "wo": _w((lambda *s: torch.randn(*s, dtype=torch.bfloat16) * 0.05)(H * Dh, D) * ((H * Dh) ** -0.5)),
        }
    _A_in = _A_setup()

    def _B_setup():
        B, Sq, D = 16, 80, 512
        H, Sk, Dh = 32, 80, 128
        return {
            "x": _w((lambda *s: torch.randn(*s, dtype=torch.bfloat16) * 0.8)(B, Sq, D)),
            "k_cache": _w((lambda *s: torch.randn(*s, dtype=torch.bfloat16) * 0.8)(B, H, Sk, Dh)),
            "v_cache": _w((lambda *s: torch.randn(*s, dtype=torch.bfloat16) * 0.05)(B, H, Sk, Dh)),
            "wq": _w((lambda *s: torch.randn(*s, dtype=torch.bfloat16) * 0.8)(D, H * Dh) * (D ** -0.5)),
            "wo": _w((lambda *s: torch.randn(*s, dtype=torch.bfloat16) * 0.05)(H * Dh, D) * ((H * Dh) ** -0.5)),
        }
    _B_in = _B_setup()

    return {
        "A_x": _A_in["x"],
        "A_k_cache": _A_in["k_cache"],
        "A_v_cache": _A_in["v_cache"],
        "A_wq": _A_in["wq"],
        "A_wo": _A_in["wo"],
        "B_x": _B_in["x"],
        "B_k_cache": _B_in["k_cache"],
        "B_v_cache": _B_in["v_cache"],
        "B_wq": _B_in["wq"],
        "B_wo": _B_in["wo"],
    }

def reference(A_x, A_k_cache, A_v_cache, A_wq, A_wo, B_x, B_k_cache, B_v_cache, B_wq, B_wo):
    def _A_ref(x, k_cache, v_cache, wq, wo):
        B, Sq, D = x.shape
        H, Dh = 32, 128
        q = (lambda x, *d: x.permute(*d))((x @ wq).reshape(B, Sq, H, Dh), 0, 2, 1, 3)
        scores = torch.einsum("bhqd,bhkd->bhqk", q, k_cache) * (Dh ** -0.5)
        p = _softmax(scores, axis=-1)
        o = torch.einsum("bhqk,bhkd->bhqd", p, v_cache)
        return (lambda x, *d: x.permute(*d))(o, 0, 2, 1, 3).reshape(B, Sq, H * Dh) @ wo

    def _B_ref(x, k_cache, v_cache, wq, wo):
        B, Sq, D = x.shape
        H, Dh = 32, 128
        q = (lambda x, *d: x.permute(*d))((x @ wq).reshape(B, Sq, H, Dh), 0, 2, 1, 3)
        scores = torch.einsum("bhqd,bhkd->bhqk", q, k_cache) * (Dh ** -0.5)
        p = _softmax(scores, axis=-1)
        o = torch.einsum("bhqk,bhkd->bhqd", p, v_cache)
        return (lambda x, *d: x.permute(*d))(o, 0, 2, 1, 3).reshape(B, Sq, H * Dh) @ wo

    a = _A_ref(A_x, A_k_cache, A_v_cache, A_wq, A_wo)
    b = _B_ref(B_x, B_k_cache, B_v_cache, B_wq, B_wo)
    return torch.concatenate([a, b], axis=-1)
```

```asm
; @launch grid=(256,1,1) block=(256,1,1) lds=163840
.amdgcn_target "amdgcn-amd-amdhsa--gfx950"
.text
.globl concat_heads__mha_block_cached__mha_block_cached__near_ridge_kernel
.p2align 8
.type concat_heads__mha_block_cached__mha_block_cached__near_ridge_kernel,@function
concat_heads__mha_block_cached__mha_block_cached__near_ridge_kernel:
    s_cmpk_ge_u32 s2, 0x100
    s_cbranch_scc1 L_end
    s_bitcmp1_b32 s2, 2
    s_cselect_b32 s5, 40, 0
    s_add_u32 s6, s0, s5
    s_addc_u32 s7, s1, 0
    s_load_dwordx2 s[8:9], s[6:7], 0
    s_load_dwordx2 s[20:21], s[6:7], 24
    v_lshrrev_b32 v1, 6, v0
    s_lshr_b32 s48, s2, 4
    v_readfirstlane_b32 s47, v1
    s_lshr_b32 s4, s2, 3
    s_and_b32 s4, s4, 1
    s_and_b32 s3, s2, 3
    s_lshl1_add_u32 s49, s3, s4
    s_lshl3_add_u32 s4, s4, s48
    s_lshl1_add_u32 s3, s3, s4
    s_and_b32 s51, s3, 14
    v_and_b32 v0, 63, v0
    v_and_b32 v4, 15, v0
    v_lshrrev_b32 v5, 4, v0
    s_movk_i32 s37, 0x2000
    s_movk_i32 s38, 0x4000
    s_movk_i32 s39, 0x6000
    s_lshl_b32 s40, s38, 1
    s_add_u32 s41, s40, s37
    s_add_u32 s42, s40, s38
    s_add_u32 s43, s40, s39
    s_lshl_b32 s58, s40, 1
    s_lshl2_add_u32 s5, s49, s47
    s_lshl_b32 s3, s51, 10
    s_add_u32 s3, s3, s5
    s_lshl_b32 s3, s3, 8
    v_lshl_add_u32 v6, v5, 12, v4
    v_lshl_add_u32 v1, v6, 4, s3
    v_lshl_add_u32 v6, s47, 2, v5
    v_xor_b32 v7, v4, v6
    s_lshl_b32 s3, s51, 2
    v_add_u32 v7, s3, v7
    v_lshlrev_b32 v253, 4, v7
    v_and_b32 v7, 63, v7
    v_lshlrev_b32 v252, 10, v6
    v_lshl_add_u32 v254, v7, 4, v252
    s_mov_b32 s10, 81920
    s_mul_i32 s3, s48, s10
    s_lshl_b32 s57, s47, 10
    s_mov_b32 m0, s57
    s_movk_i32 s4, 0x1000
    s_mov_b32 s11, 0x20000
    s_mov_b32 s23, s11
    s_lshl_b32 s22, s11, 5
    s_waitcnt lgkmcnt(0)
    s_add_u32 s8, s8, s3
    s_addc_u32 s9, s9, 0
    buffer_load_dwordx4 v254, s[8:11], 0 offen  lds
    s_add_u32 m0, m0, s4
    buffer_load_dwordx4 v[16:19], v1, s[20:23], 0 offen
    buffer_load_dwordx4 v254, s[8:11], s38 offen  lds
    s_add_u32 m0, m0, s4
    buffer_load_dwordx4 v[20:23], v1, s[20:23], s37 offen
    buffer_load_dwordx4 v254, s[8:11], s40 offen  lds
    s_add_u32 m0, m0, s4
    buffer_load_dwordx4 v[24:27], v1, s[20:23], s38 offen
    buffer_load_dwordx4 v254, s[8:11], s42 offen  lds
    s_add_u32 m0, m0, s4
    buffer_load_dwordx4 v[28:31], v1, s[20:23], s39 offen
    buffer_load_dwordx4 v254, s[8:11], s58 offen  lds
    buffer_load_dwordx4 v[32:35], v1, s[20:23], s40 offen
    buffer_load_dwordx4 v[36:39], v1, s[20:23], s41 offen
    buffer_load_dwordx4 v[40:43], v1, s[20:23], s42 offen
    buffer_load_dwordx4 v[44:47], v1, s[20:23], s43 offen
    v_add_u32 v1, 0x40000, v1
    v_and_b32 v1, 0x3fffff, v1
    s_load_dwordx2 s[12:13], s[6:7], 8
    s_load_dwordx2 s[16:17], s[6:7], 16
    s_load_dwordx2 s[24:25], s[6:7], 32
    s_load_dwordx2 s[32:33], s[0:1], 80
    s_load_dwordx2 s[52:53], s[0:1], 88
    s_load_dwordx2 s[28:29], s[0:1], 96
    s_bfe_u32 s50, s2, 0x10002
    s_lshl_b32 s3, s48, 5
    s_add_u32 s5, s5, s3
    s_mul_i32 s5, s5, 20480
    s_getpc_b64 s[96:97]
L_pc:
    s_lshr_b32 s3, s2, 3
    s_lshl_b32 s3, s3, 2
    s_add_u32 s3, s3, s47
    s_mul_i32 s3, s3, 384
    v_lshl_add_u32 v242, v0, 7, s3
    v_min_u32 v242, L_end-L_pc, v242
    s_mov_b64 exec, 7
    global_load_dword v243, v242, s[96:97]
    s_mov_b64 exec, -1
    buffer_load_dwordx4 v[48:51], v1, s[20:23], 0 offen
    buffer_load_dwordx4 v[52:55], v1, s[20:23], s37 offen
    buffer_load_dwordx4 v[56:59], v1, s[20:23], s38 offen
    buffer_load_dwordx4 v[60:63], v1, s[20:23], s39 offen
    buffer_load_dwordx4 v[64:67], v1, s[20:23], s40 offen
    buffer_load_dwordx4 v[68:71], v1, s[20:23], s41 offen
    buffer_load_dwordx4 v[72:75], v1, s[20:23], s42 offen
    buffer_load_dwordx4 v[76:79], v1, s[20:23], s43 offen
    v_add_u32 v1, 0x40000, v1
    v_and_b32 v1, 0x3fffff, v1
    s_waitcnt lgkmcnt(0)
    s_mov_b32 s44, 0x05040100
    s_mov_b32 s45, 0x07060302
    s_mov_b32 s46, 0x3e0293ee
    s_lshl_b32 s3, s50, 4
    s_add_u32 s56, s3, s48
    s_mul_i32 s4, s47, 20480
    s_add_u32 s4, s4, 81920
    s_add_u32 s12, s12, s5
    s_addc_u32 s13, s13, 0
    s_mov_b32 s14, 20480
    s_mov_b32 s15, 0x20000
    s_add_u32 s16, s16, s5
    s_addc_u32 s17, s17, 0
    s_mov_b32 s18, 20480
    s_mov_b32 s19, 0x20000
    s_lshl_b32 s3, s49, 19
    s_add_u32 s24, s24, s3
    s_addc_u32 s25, s25, 0
    s_mov_b32 s26, 524288
    s_mov_b32 s27, 0x20000
    s_add_u32 s96, s28, 25165824
    s_addc_u32 s97, s29, 0
    s_lshl_b32 s3, s56, 12
    s_add_u32 s96, s96, s3
    s_addc_u32 s97, s97, 0
    s_mul_i32 s3, s56, 655360
    s_add_u32 s3, s3, 0
    s_add_u32 s28, s28, s3
    s_addc_u32 s29, s29, 0
    s_mov_b32 s30, 655360
    s_mov_b32 s31, 0x20000
    s_mov_b32 s34, 2621440
    s_mov_b32 s35, 0x20000
    s_mov_b32 s54, 256
    s_mov_b32 s55, 0x20000
    s_mul_i32 s3, s48, 163840
    buffer_load_dword v244, off, s[12:15], 0
    buffer_load_dword v244, off, s[16:19], 0
    buffer_load_dword v244, off, s[24:27], 0
    buffer_load_dword v244, off, s[28:31], 0
    buffer_load_dword v244, off, s[32:35], s3
    v_xor_b32 v7, v5, v4
    v_lshlrev_b32 v7, 4, v7
    v_lshl_add_u32 v2, v4, 8, v7
    v_lshl_add_u32 v4, v5, 8, v7
    v_xor_b32 v5, 0xc0, v4
    v_xor_b32 v6, 0x80, v4
    v_xor_b32 v7, 0x40, v4
    s_lshl_b32 s3, s49, 2
    s_lshl_b32 s5, s47, 9
    s_add_u32 s3, s3, s5
    v_lshl_add_u32 v240, v0, 7, s3
    v_mov_b32 v241, 0
    s_waitcnt vmcnt(18)
    s_barrier
    ds_read_b128 a[64:67], v2 offset:0
    ds_read_b128 a[68:71], v2 offset:4096
    ds_read_b128 a[72:75], v2 offset:8192
    ds_read_b128 a[76:79], v2 offset:12288
    ds_read_b128 a[80:83], v2 offset:16384
    s_mov_b64 exec, 15
    global_store_dword v240, v241, s[96:97] sc1
    s_mov_b64 exec, -1
    s_waitcnt vmcnt(15)
    v_perm_b32 v8, v20, v16, s44
    v_perm_b32 v9, v28, v24, s44
    v_perm_b32 v10, v36, v32, s44
    v_perm_b32 v11, v44, v40, s44
    s_waitcnt lgkmcnt(4)
    s_nop 0
    v_mfma_f32_16x16x32_bf16 v[144:147], v[8:11], a[64:67], 0
    buffer_load_dwordx4 v[80:83], v1, s[20:23], 0 offen
    buffer_load_dwordx4 v[84:87], v1, s[20:23], s37 offen
    s_waitcnt lgkmcnt(3)
    v_mfma_f32_16x16x32_bf16 v[176:179], v[8:11], a[68:71], 0
    v_perm_b32 v12, v20, v16, s45
    v_perm_b32 v13, v28, v24, s45
    s_waitcnt lgkmcnt(0)
    v_mfma_f32_16x16x32_bf16 v[208:211], v[8:11], a[72:75], 0
    v_perm_b32 v14, v36, v32, s45
    v_perm_b32 v15, v44, v40, s45
    v_mfma_f32_16x16x32_bf16 a[0:3], v[8:11], a[76:79], 0
    v_mfma_f32_16x16x32_bf16 a[32:35], v[8:11], a[80:83], 0
    v_mfma_f32_16x16x32_bf16 a[36:39], v[12:15], a[80:83], 0
    buffer_load_dwordx4 v[88:91], v1, s[20:23], s38 offen
    v_perm_b32 v8, v21, v17, s44
    v_mfma_f32_16x16x32_bf16 a[4:7], v[12:15], a[76:79], 0
    v_perm_b32 v9, v29, v25, s44
    v_perm_b32 v10, v37, v33, s44
    v_mfma_f32_16x16x32_bf16 v[212:215], v[12:15], a[72:75], 0
    v_perm_b32 v11, v45, v41, s44
    v_mfma_f32_16x16x32_bf16 v[180:183], v[12:15], a[68:71], 0
    v_mfma_f32_16x16x32_bf16 v[148:151], v[12:15], a[64:67], 0
    v_mfma_f32_16x16x32_bf16 v[152:155], v[8:11], a[64:67], 0
    buffer_load_dwordx4 v[92:95], v1, s[20:23], s39 offen
    buffer_load_dwordx4 v[96:99], v1, s[20:23], s40 offen
    v_mfma_f32_16x16x32_bf16 v[184:187], v[8:11], a[68:71], 0
    v_perm_b32 v12, v21, v17, s45
    v_perm_b32 v13, v29, v25, s45
    v_mfma_f32_16x16x32_bf16 v[216:219], v[8:11], a[72:75], 0
    v_perm_b32 v14, v37, v33, s45
    v_perm_b32 v15, v45, v41, s45
    v_mfma_f32_16x16x32_bf16 a[8:11], v[8:11], a[76:79], 0
    v_xor_b32 v2, 64, v2
    v_mfma_f32_16x16x32_bf16 a[40:43], v[8:11], a[80:83], 0
    ds_read_b128 a[84:87], v2 offset:0
    v_mfma_f32_16x16x32_bf16 a[44:47], v[12:15], a[80:83], 0
    ds_read_b128 a[88:91], v2 offset:4096
    buffer_load_dwordx4 v[100:103], v1, s[20:23], s41 offen
    v_mfma_f32_16x16x32_bf16 a[12:15], v[12:15], a[76:79], 0
    v_perm_b32 v8, v22, v18, s44
    v_perm_b32 v9, v30, v26, s44
    v_mfma_f32_16x16x32_bf16 v[220:223], v[12:15], a[72:75], 0
    v_perm_b32 v10, v38, v34, s44
    v_perm_b32 v11, v46, v42, s44
    v_mfma_f32_16x16x32_bf16 v[188:191], v[12:15], a[68:71], 0
    v_mfma_f32_16x16x32_bf16 v[156:159], v[12:15], a[64:67], 0
    v_mfma_f32_16x16x32_bf16 v[160:163], v[8:11], a[64:67], 0
    ds_read_b128 a[92:95], v2 offset:8192
    buffer_load_dwordx4 v[104:107], v1, s[20:23], s42 offen
    v_mfma_f32_16x16x32_bf16 v[192:195], v[8:11], a[68:71], 0
    buffer_load_dwordx4 v[108:111], v1, s[20:23], s43 offen
    v_perm_b32 v12, v22, v18, s45
    v_mfma_f32_16x16x32_bf16 v[224:227], v[8:11], a[72:75], 0
    v_perm_b32 v13, v30, v26, s45
    v_perm_b32 v14, v38, v34, s45
    v_mfma_f32_16x16x32_bf16 a[16:19], v[8:11], a[76:79], 0
    v_perm_b32 v15, v46, v42, s45
    v_add_u32 v1, 0x40000, v1
    v_mfma_f32_16x16x32_bf16 a[48:51], v[8:11], a[80:83], 0
    v_and_b32 v1, 0x3fffff, v1
    v_mfma_f32_16x16x32_bf16 a[52:55], v[12:15], a[80:83], 0
    ds_read_b128 a[96:99], v2 offset:12288
    buffer_load_dwordx4 v[112:115], v1, s[20:23], 0 offen
    v_mfma_f32_16x16x32_bf16 a[20:23], v[12:15], a[76:79], 0
    v_perm_b32 v8, v23, v19, s44
    v_perm_b32 v9, v31, v27, s44
    v_mfma_f32_16x16x32_bf16 v[228:231], v[12:15], a[72:75], 0
    v_perm_b32 v10, v39, v35, s44
    v_perm_b32 v11, v47, v43, s44
    v_mfma_f32_16x16x32_bf16 v[196:199], v[12:15], a[68:71], 0
    v_mfma_f32_16x16x32_bf16 v[164:167], v[12:15], a[64:67], 0
    v_mfma_f32_16x16x32_bf16 v[168:171], v[8:11], a[64:67], 0
    ds_read_b128 a[100:103], v2 offset:16384
    buffer_load_dwordx4 v[116:119], v1, s[20:23], s37 offen
    v_mfma_f32_16x16x32_bf16 v[200:203], v[8:11], a[68:71], 0
    buffer_load_dwordx4 v[120:123], v1, s[20:23], s38 offen
    s_add_u32 m0, s57, 20480
    v_mfma_f32_16x16x32_bf16 v[232:235], v[8:11], a[72:75], 0
    v_perm_b32 v12, v23, v19, s45
    v_perm_b32 v13, v31, v27, s45
    v_mfma_f32_16x16x32_bf16 a[24:27], v[8:11], a[76:79], 0
    v_perm_b32 v14, v39, v35, s45
    v_perm_b32 v15, v47, v43, s45
    v_mfma_f32_16x16x32_bf16 a[56:59], v[8:11], a[80:83], 0
    v_add_u32 v253, 256, v253
    v_and_b32 v254, 0x3ff, v253
    v_or_b32 v254, v254, v252
    s_nop 0
    buffer_load_dwordx4 v254, s[8:11], 0 offen  lds
    s_add_u32 m0, s57, 24576
    s_nop 0
    buffer_load_dwordx4 v254, s[8:11], s38 offen  lds
    s_add_u32 m0, s57, 28672
    s_nop 0
    buffer_load_dwordx4 v254, s[8:11], s40 offen  lds
    s_add_u32 m0, s57, 32768
    s_nop 0
    buffer_load_dwordx4 v254, s[8:11], s42 offen  lds
    s_add_u32 m0, s57, 36864
    s_nop 0
    buffer_load_dwordx4 v254, s[8:11], s58 offen  lds
    v_mfma_f32_16x16x32_bf16 a[60:63], v[12:15], a[80:83], 0
    buffer_load_dwordx4 v[124:127], v1, s[20:23], s39 offen
    s_waitcnt vmcnt(23)
    v_perm_b32 v8, v52, v48, s44
    v_mfma_f32_16x16x32_bf16 a[28:31], v[12:15], a[76:79], 0
    v_perm_b32 v9, v60, v56, s44
    v_perm_b32 v10, v68, v64, s44
    v_mfma_f32_16x16x32_bf16 v[236:239], v[12:15], a[72:75], 0
    v_perm_b32 v11, v76, v72, s44
    v_mfma_f32_16x16x32_bf16 v[204:207], v[12:15], a[68:71], 0
    v_mfma_f32_16x16x32_bf16 v[172:175], v[12:15], a[64:67], 0
    s_waitcnt lgkmcnt(0)
    v_mfma_f32_16x16x32_bf16 v[144:147], v[8:11], a[84:87], v[144:147]
    buffer_load_dwordx4 v[128:131], v1, s[20:23], s40 offen
    buffer_load_dwordx4 v[132:135], v1, s[20:23], s41 offen
    v_mfma_f32_16x16x32_bf16 v[176:179], v[8:11], a[88:91], v[176:179]
    v_perm_b32 v12, v52, v48, s45
    v_perm_b32 v13, v60, v56, s45
    v_mfma_f32_16x16x32_bf16 v[208:211], v[8:11], a[92:95], v[208:211]
    v_perm_b32 v14, v68, v64, s45
    v_perm_b32 v15, v76, v72, s45
    v_mfma_f32_16x16x32_bf16 a[0:3], v[8:11], a[96:99], a[0:3]
    v_mfma_f32_16x16x32_bf16 a[32:35], v[8:11], a[100:103], a[32:35]
    v_mfma_f32_16x16x32_bf16 a[36:39], v[12:15], a[100:103], a[36:39]
    buffer_load_dwordx4 v[136:139], v1, s[20:23], s42 offen
    v_perm_b32 v8, v53, v49, s44
    v_mfma_f32_16x16x32_bf16 a[4:7], v[12:15], a[96:99], a[4:7]
    v_perm_b32 v9, v61, v57, s44
    v_perm_b32 v10, v69, v65, s44
    v_mfma_f32_16x16x32_bf16 v[212:215], v[12:15], a[92:95], v[212:215]
    v_perm_b32 v11, v77, v73, s44
    v_mfma_f32_16x16x32_bf16 v[180:183], v[12:15], a[88:91], v[180:183]
    v_mfma_f32_16x16x32_bf16 v[148:151], v[12:15], a[84:87], v[148:151]
    v_mfma_f32_16x16x32_bf16 v[152:155], v[8:11], a[84:87], v[152:155]
    buffer_load_dwordx4 v[140:143], v1, s[20:23], s43 offen
    v_perm_b32 v12, v53, v49, s45
    v_mfma_f32_16x16x32_bf16 v[184:187], v[8:11], a[88:91], v[184:187]
    v_perm_b32 v13, v61, v57, s45
    v_perm_b32 v14, v69, v65, s45
    v_mfma_f32_16x16x32_bf16 v[216:219], v[8:11], a[92:95], v[216:219]
    v_perm_b32 v15, v77, v73, s45
    v_xor_b32 v2, 192, v2
    v_mfma_f32_16x16x32_bf16 a[8:11], v[8:11], a[96:99], a[8:11]
    ds_read_b128 a[64:67], v2 offset:0
    v_add_u32 v1, 0x40000, v1
    v_mfma_f32_16x16x32_bf16 a[40:43], v[8:11], a[100:103], a[40:43]
    v_and_b32 v1, 0x3fffff, v1
    buffer_load_dwordx4 v[16:19], v1, s[20:23], 0 offen
    v_mfma_f32_16x16x32_bf16 a[44:47], v[12:15], a[100:103], a[44:47]
    ds_read_b128 a[68:71], v2 offset:4096
    buffer_load_dwordx4 v[20:23], v1, s[20:23], s37 offen
    v_mfma_f32_16x16x32_bf16 a[12:15], v[12:15], a[96:99], a[12:15]
    v_perm_b32 v8, v54, v50, s44
    v_perm_b32 v9, v62, v58, s44
    v_mfma_f32_16x16x32_bf16 v[220:223], v[12:15], a[92:95], v[220:223]
    v_perm_b32 v10, v70, v66, s44
    v_perm_b32 v11, v78, v74, s44
    v_mfma_f32_16x16x32_bf16 v[188:191], v[12:15], a[88:91], v[188:191]
    v_mfma_f32_16x16x32_bf16 v[156:159], v[12:15], a[84:87], v[156:159]
    v_mfma_f32_16x16x32_bf16 v[160:163], v[8:11], a[84:87], v[160:163]
    ds_read_b128 a[72:75], v2 offset:8192
    buffer_load_dwordx4 v[24:27], v1, s[20:23], s38 offen
    v_mfma_f32_16x16x32_bf16 v[192:195], v[8:11], a[88:91], v[192:195]
    buffer_load_dwordx4 v[28:31], v1, s[20:23], s39 offen
    v_perm_b32 v12, v54, v50, s45
    v_mfma_f32_16x16x32_bf16 v[224:227], v[8:11], a[92:95], v[224:227]
    v_perm_b32 v13, v62, v58, s45
    v_perm_b32 v14, v70, v66, s45
    v_mfma_f32_16x16x32_bf16 a[16:19], v[8:11], a[96:99], a[16:19]
    v_perm_b32 v15, v78, v74, s45
    v_mfma_f32_16x16x32_bf16 a[48:51], v[8:11], a[100:103], a[48:51]
    s_nop 0
    v_mfma_f32_16x16x32_bf16 a[52:55], v[12:15], a[100:103], a[52:55]
    ds_read_b128 a[76:79], v2 offset:12288
    buffer_load_dwordx4 v[32:35], v1, s[20:23], s40 offen
    v_mfma_f32_16x16x32_bf16 a[20:23], v[12:15], a[96:99], a[20:23]
    v_perm_b32 v8, v55, v51, s44
    v_perm_b32 v9, v63, v59, s44
    v_mfma_f32_16x16x32_bf16 v[228:231], v[12:15], a[92:95], v[228:231]
    v_perm_b32 v10, v71, v67, s44
    v_perm_b32 v11, v79, v75, s44
    v_mfma_f32_16x16x32_bf16 v[196:199], v[12:15], a[88:91], v[196:199]
    v_mfma_f32_16x16x32_bf16 v[164:167], v[12:15], a[84:87], v[164:167]
    v_mfma_f32_16x16x32_bf16 v[168:171], v[8:11], a[84:87], v[168:171]
    ds_read_b128 a[80:83], v2 offset:16384
    buffer_load_dwordx4 v[36:39], v1, s[20:23], s41 offen
    v_mfma_f32_16x16x32_bf16 v[200:203], v[8:11], a[88:91], v[200:203]
    buffer_load_dwordx4 v[40:43], v1, s[20:23], s42 offen
    v_perm_b32 v12, v55, v51, s45
    v_mfma_f32_16x16x32_bf16 v[232:235], v[8:11], a[92:95], v[232:235]
    v_perm_b32 v13, v63, v59, s45
    v_perm_b32 v14, v71, v67, s45
    v_mfma_f32_16x16x32_bf16 a[24:27], v[8:11], a[96:99], a[24:27]
    v_perm_b32 v15, v79, v75, s45
    v_mfma_f32_16x16x32_bf16 a[56:59], v[8:11], a[100:103], a[56:59]
    s_nop 0
    v_mfma_f32_16x16x32_bf16 a[60:63], v[12:15], a[100:103], a[60:63]
    buffer_load_dwordx4 v[44:47], v1, s[20:23], s43 offen
    s_waitcnt vmcnt(21)
    v_perm_b32 v8, v84, v80, s44
    v_mfma_f32_16x16x32_bf16 a[28:31], v[12:15], a[96:99], a[28:31]
    v_perm_b32 v9, v92, v88, s44
    v_perm_b32 v10, v100, v96, s44
    v_mfma_f32_16x16x32_bf16 v[236:239], v[12:15], a[92:95], v[236:239]
    v_perm_b32 v11, v108, v104, s44
    v_add_u32 v1, 0x40000, v1
    v_mfma_f32_16x16x32_bf16 v[204:207], v[12:15], a[88:91], v[204:207]
    v_and_b32 v1, 0x3fffff, v1
    v_mfma_f32_16x16x32_bf16 v[172:175], v[12:15], a[84:87], v[172:175]
    s_waitcnt lgkmcnt(0)
    v_mfma_f32_16x16x32_bf16 v[144:147], v[8:11], a[64:67], v[144:147]
    s_add_u32 m0, s4, 0
    s_mov_b32 s7, 0
    v_mfma_f32_16x16x32_bf16 v[176:179], v[8:11], a[68:71], v[176:179]
    buffer_load_dwordx4 v4, s[12:15], s7 offen offset:0 nt lds
    buffer_load_dwordx4 v5, s[12:15], s7 offen offset:1024 nt lds
    v_mfma_f32_16x16x32_bf16 v[208:211], v[8:11], a[72:75], v[208:211]
    buffer_load_dwordx4 v6, s[12:15], s7 offen offset:2048 nt lds
    buffer_load_dwordx4 v7, s[12:15], s7 offen offset:3072 nt lds
    v_mfma_f32_16x16x32_bf16 a[0:3], v[8:11], a[76:79], a[0:3]
    s_add_u32 m0, s4, 4096
    s_mov_b32 s7, 4096
    v_mfma_f32_16x16x32_bf16 a[32:35], v[8:11], a[80:83], a[32:35]
    buffer_load_dwordx4 v4, s[12:15], s7 offen offset:0 nt lds
    buffer_load_dwordx4 v5, s[12:15], s7 offen offset:1024 nt lds
    v_perm_b32 v12, v84, v80, s45
    v_perm_b32 v13, v92, v88, s45
    v_perm_b32 v14, v100, v96, s45
    v_perm_b32 v15, v108, v104, s45
    buffer_load_dwordx4 v6, s[12:15], s7 offen offset:2048 nt lds
    s_nop 0
    v_mfma_f32_16x16x32_bf16 a[36:39], v[12:15], a[80:83], a[36:39]
    v_perm_b32 v8, v85, v81, s44
    v_perm_b32 v9, v93, v89, s44
    v_mfma_f32_16x16x32_bf16 a[4:7], v[12:15], a[76:79], a[4:7]
    v_perm_b32 v10, v101, v97, s44
    v_perm_b32 v11, v109, v105, s44
    v_mfma_f32_16x16x32_bf16 v[212:215], v[12:15], a[72:75], v[212:215]
    v_mfma_f32_16x16x32_bf16 v[180:183], v[12:15], a[68:71], v[180:183]
    v_mfma_f32_16x16x32_bf16 v[148:151], v[12:15], a[64:67], v[148:151]
    v_mfma_f32_16x16x32_bf16 v[152:155], v[8:11], a[64:67], v[152:155]
    v_perm_b32 v12, v85, v81, s45
    v_perm_b32 v13, v93, v89, s45
    v_mfma_f32_16x16x32_bf16 v[184:187], v[8:11], a[68:71], v[184:187]
    v_perm_b32 v14, v101, v97, s45
    v_perm_b32 v15, v109, v105, s45
    v_mfma_f32_16x16x32_bf16 v[216:219], v[8:11], a[72:75], v[216:219]
    v_xor_b32 v2, 64, v2
    v_mfma_f32_16x16x32_bf16 a[8:11], v[8:11], a[76:79], a[8:11]
    ds_read_b128 a[84:87], v2 offset:0
    v_mfma_f32_16x16x32_bf16 a[40:43], v[8:11], a[80:83], a[40:43]
    v_mfma_f32_16x16x32_bf16 a[44:47], v[12:15], a[80:83], a[44:47]
    ds_read_b128 a[88:91], v2 offset:4096
    v_perm_b32 v8, v86, v82, s44
    v_mfma_f32_16x16x32_bf16 a[12:15], v[12:15], a[76:79], a[12:15]
    v_perm_b32 v9, v94, v90, s44
    v_perm_b32 v10, v102, v98, s44
    v_mfma_f32_16x16x32_bf16 v[220:223], v[12:15], a[72:75], v[220:223]
    v_perm_b32 v11, v110, v106, s44
    v_mfma_f32_16x16x32_bf16 v[188:191], v[12:15], a[68:71], v[188:191]
    v_mfma_f32_16x16x32_bf16 v[156:159], v[12:15], a[64:67], v[156:159]
    v_mfma_f32_16x16x32_bf16 v[160:163], v[8:11], a[64:67], v[160:163]
    ds_read_b128 a[92:95], v2 offset:8192
    v_perm_b32 v12, v86, v82, s45
    v_mfma_f32_16x16x32_bf16 v[192:195], v[8:11], a[68:71], v[192:195]
    v_perm_b32 v13, v94, v90, s45
    v_perm_b32 v14, v102, v98, s45
    v_mfma_f32_16x16x32_bf16 v[224:227], v[8:11], a[72:75], v[224:227]
    v_perm_b32 v15, v110, v106, s45
    v_mfma_f32_16x16x32_bf16 a[16:19], v[8:11], a[76:79], a[16:19]
    v_mfma_f32_16x16x32_bf16 a[48:51], v[8:11], a[80:83], a[48:51]
    v_mfma_f32_16x16x32_bf16 a[52:55], v[12:15], a[80:83], a[52:55]
    ds_read_b128 a[96:99], v2 offset:12288
    v_perm_b32 v8, v87, v83, s44
    v_mfma_f32_16x16x32_bf16 a[20:23], v[12:15], a[76:79], a[20:23]
    v_perm_b32 v9, v95, v91, s44
    v_perm_b32 v10, v103, v99, s44
    v_mfma_f32_16x16x32_bf16 v[228:231], v[12:15], a[72:75], v[228:231]
    v_perm_b32 v11, v111, v107, s44
    v_mfma_f32_16x16x32_bf16 v[196:199], v[12:15], a[68:71], v[196:199]
    v_mfma_f32_16x16x32_bf16 v[164:167], v[12:15], a[64:67], v[164:167]
    v_mfma_f32_16x16x32_bf16 v[168:171], v[8:11], a[64:67], v[168:171]
    ds_read_b128 a[100:103], v2 offset:16384
    v_perm_b32 v12, v87, v83, s45
    v_mfma_f32_16x16x32_bf16 v[200:203], v[8:11], a[68:71], v[200:203]
    v_perm_b32 v13, v95, v91, s45
    v_perm_b32 v14, v103, v99, s45
    v_mfma_f32_16x16x32_bf16 v[232:235], v[8:11], a[72:75], v[232:235]
    v_perm_b32 v15, v111, v107, s45
    v_mfma_f32_16x16x32_bf16 a[24:27], v[8:11], a[76:79], a[24:27]
    v_mfma_f32_16x16x32_bf16 a[56:59], v[8:11], a[80:83], a[56:59]
    v_mfma_f32_16x16x32_bf16 a[60:63], v[12:15], a[80:83], a[60:63]
    s_waitcnt vmcnt(15)
    v_perm_b32 v8, v116, v112, s44
    v_perm_b32 v9, v124, v120, s44
    v_mfma_f32_16x16x32_bf16 a[28:31], v[12:15], a[76:79], a[28:31]
    v_perm_b32 v10, v132, v128, s44
    v_perm_b32 v11, v140, v136, s44
    v_mfma_f32_16x16x32_bf16 v[236:239], v[12:15], a[72:75], v[236:239]
    v_mfma_f32_16x16x32_bf16 v[204:207], v[12:15], a[68:71], v[204:207]
    v_mfma_f32_16x16x32_bf16 v[172:175], v[12:15], a[64:67], v[172:175]
    s_waitcnt lgkmcnt(0)
    v_mfma_f32_16x16x32_bf16 v[144:147], v[8:11], a[84:87], v[144:147]
    buffer_load_dwordx4 v[48:51], v1, s[20:23], 0 offen
    buffer_load_dwordx4 v[52:55], v1, s[20:23], s37 offen
    v_mfma_f32_16x16x32_bf16 v[176:179], v[8:11], a[88:91], v[176:179]
    s_add_u32 m0, s57, 40960
    v_perm_b32 v12, v116, v112, s45
    v_mfma_f32_16x16x32_bf16 v[208:211], v[8:11], a[92:95], v[208:211]
    v_perm_b32 v13, v124, v120, s45
    v_perm_b32 v14, v132, v128, s45
    v_mfma_f32_16x16x32_bf16 a[0:3], v[8:11], a[96:99], a[0:3]
    v_perm_b32 v15, v140, v136, s45
    v_add_u32 v253, 256, v253
    v_mfma_f32_16x16x32_bf16 a[32:35], v[8:11], a[100:103], a[32:35]
    v_and_b32 v254, 0x3ff, v253
    v_or_b32 v254, v254, v252
    s_nop 0
    buffer_load_dwordx4 v254, s[8:11], 0 offen  lds
    s_add_u32 m0, s57, 45056
    v_mfma_f32_16x16x32_bf16 a[36:39], v[12:15], a[100:103], a[36:39]
    buffer_load_dwordx4 v[56:59], v1, s[20:23], s38 offen
    v_perm_b32 v8, v117, v113, s44
    v_mfma_f32_16x16x32_bf16 a[4:7], v[12:15], a[96:99], a[4:7]
    v_perm_b32 v9, v125, v121, s44
    v_perm_b32 v10, v133, v129, s44
    v_mfma_f32_16x16x32_bf16 v[212:215], v[12:15], a[92:95], v[212:215]
    v_perm_b32 v11, v141, v137, s44
    v_mfma_f32_16x16x32_bf16 v[180:183], v[12:15], a[88:91], v[180:183]
    v_mfma_f32_16x16x32_bf16 v[148:151], v[12:15], a[84:87], v[148:151]
    v_mfma_f32_16x16x32_bf16 v[152:155], v[8:11], a[84:87], v[152:155]
    s_barrier
    buffer_load_dwordx4 v[60:63], v1, s[20:23], s39 offen
    v_mfma_f32_16x16x32_bf16 v[184:187], v[8:11], a[88:91], v[184:187]
    buffer_load_dwordx4 v[64:67], v1, s[20:23], s40 offen
    buffer_load_dwordx4 v254, s[8:11], s38 offen  lds
    v_mfma_f32_16x16x32_bf16 v[216:219], v[8:11], a[92:95], v[216:219]
    s_add_u32 m0, s57, 49152
    v_perm_b32 v12, v117, v113, s45
    v_mfma_f32_16x16x32_bf16 a[8:11], v[8:11], a[96:99], a[8:11]
    v_perm_b32 v13, v125, v121, s45
    v_perm_b32 v14, v133, v129, s45
    v_mfma_f32_16x16x32_bf16 a[40:43], v[8:11], a[100:103], a[40:43]
    v_perm_b32 v15, v141, v137, s45
    v_xor_b32 v2, 192, v2
    ds_read_b128 a[64:67], v2 offset:20480
    v_mfma_f32_16x16x32_bf16 a[44:47], v[12:15], a[100:103], a[44:47]
    ds_read_b128 a[68:71], v2 offset:24576
    buffer_load_dwordx4 v[68:71], v1, s[20:23], s41 offen
    v_mfma_f32_16x16x32_bf16 a[12:15], v[12:15], a[96:99], a[12:15]
    v_perm_b32 v8, v118, v114, s44
    v_perm_b32 v9, v126, v122, s44
    v_mfma_f32_16x16x32_bf16 v[220:223], v[12:15], a[92:95], v[220:223]
    v_perm_b32 v10, v134, v130, s44
    v_perm_b32 v11, v142, v138, s44
    v_mfma_f32_16x16x32_bf16 v[188:191], v[12:15], a[88:91], v[188:191]
    v_mfma_f32_16x16x32_bf16 v[156:159], v[12:15], a[84:87], v[156:159]
    v_mfma_f32_16x16x32_bf16 v[160:163], v[8:11], a[84:87], v[160:163]
    ds_read_b128 a[72:75], v2 offset:28672
    buffer_load_dwordx4 v[72:75], v1, s[20:23], s42 offen
    v_mfma_f32_16x16x32_bf16 v[192:195], v[8:11], a[88:91], v[192:195]
    buffer_load_dwordx4 v254, s[8:11], s40 offen  lds
    s_add_u32 m0, s57, 53248
    v_mfma_f32_16x16x32_bf16 v[224:227], v[8:11], a[92:95], v[224:227]
    v_perm_b32 v12, v118, v114, s45
    v_perm_b32 v13, v126, v122, s45
    v_mfma_f32_16x16x32_bf16 a[16:19], v[8:11], a[96:99], a[16:19]
    v_perm_b32 v14, v134, v130, s45
    v_perm_b32 v15, v142, v138, s45
    v_mfma_f32_16x16x32_bf16 a[48:51], v[8:11], a[100:103], a[48:51]
    s_nop 0
    v_mfma_f32_16x16x32_bf16 a[52:55], v[12:15], a[100:103], a[52:55]
    ds_read_b128 a[76:79], v2 offset:32768
    buffer_load_dwordx4 v[76:79], v1, s[20:23], s43 offen
    v_mfma_f32_16x16x32_bf16 a[20:23], v[12:15], a[96:99], a[20:23]
    v_perm_b32 v8, v119, v115, s44
    v_perm_b32 v9, v127, v123, s44
    v_mfma_f32_16x16x32_bf16 v[228:231], v[12:15], a[92:95], v[228:231]
    v_perm_b32 v10, v135, v131, s44
    v_perm_b32 v11, v143, v139, s44
    v_mfma_f32_16x16x32_bf16 v[196:199], v[12:15], a[88:91], v[196:199]
    v_add_u32 v1, 0x40000, v1
    v_and_b32 v1, 0x3fffff, v1
    v_mfma_f32_16x16x32_bf16 v[164:167], v[12:15], a[84:87], v[164:167]
    buffer_load_dwordx4 v[80:83], v1, s[20:23], 0 offen
    buffer_load_dwordx4 v254, s[8:11], s42 offen  lds
    s_add_u32 m0, s57, 57344
    v_mfma_f32_16x16x32_bf16 v[168:171], v[8:11], a[84:87], v[168:171]
    ds_read_b128 a[80:83], v2 offset:36864
    buffer_load_dwordx4 v[84:87], v1, s[20:23], s37 offen
    v_mfma_f32_16x16x32_bf16 v[200:203], v[8:11], a[88:91], v[200:203]
    v_perm_b32 v12, v119, v115, s45
    v_perm_b32 v13, v127, v123, s45
    v_mfma_f32_16x16x32_bf16 v[232:235], v[8:11], a[92:95], v[232:235]
    v_perm_b32 v14, v135, v131, s45
    v_perm_b32 v15, v143, v139, s45
    v_mfma_f32_16x16x32_bf16 a[24:27], v[8:11], a[96:99], a[24:27]
    v_mfma_f32_16x16x32_bf16 a[56:59], v[8:11], a[100:103], a[56:59]
    v_mfma_f32_16x16x32_bf16 a[60:63], v[12:15], a[100:103], a[60:63]
    buffer_load_dwordx4 v[88:91], v1, s[20:23], s38 offen
    buffer_load_dwordx4 v254, s[8:11], s58 offen  lds
    v_mfma_f32_16x16x32_bf16 a[28:31], v[12:15], a[96:99], a[28:31]
    s_waitcnt vmcnt(23)
    v_perm_b32 v8, v20, v16, s44
    v_perm_b32 v9, v28, v24, s44
    v_mfma_f32_16x16x32_bf16 v[236:239], v[12:15], a[92:95], v[236:239]
    v_perm_b32 v10, v36, v32, s44
    v_perm_b32 v11, v44, v40, s44
    v_mfma_f32_16x16x32_bf16 v[204:207], v[12:15], a[88:91], v[204:207]
    v_mfma_f32_16x16x32_bf16 v[172:175], v[12:15], a[84:87], v[172:175]
    s_waitcnt lgkmcnt(0)
    v_mfma_f32_16x16x32_bf16 v[144:147], v[8:11], a[64:67], v[144:147]
    buffer_load_dwordx4 v[92:95], v1, s[20:23], s39 offen
    buffer_load_dwordx4 v[96:99], v1, s[20:23], s40 offen
    v_mfma_f32_16x16x32_bf16 v[176:179], v[8:11], a[68:71], v[176:179]
    v_perm_b32 v12, v20, v16, s45
    v_perm_b32 v13, v28, v24, s45
    v_mfma_f32_16x16x32_bf16 v[208:211], v[8:11], a[72:75], v[208:211]
    v_perm_b32 v14, v36, v32, s45
    v_perm_b32 v15, v44, v40, s45
    v_mfma_f32_16x16x32_bf16 a[0:3], v[8:11], a[76:79], a[0:3]
    v_mfma_f32_16x16x32_bf16 a[32:35], v[8:11], a[80:83], a[32:35]
    v_mfma_f32_16x16x32_bf16 a[36:39], v[12:15], a[80:83], a[36:39]
    buffer_load_dwordx4 v[100:103], v1, s[20:23], s41 offen
    v_perm_b32 v8, v21, v17, s44
    v_mfma_f32_16x16x32_bf16 a[4:7], v[12:15], a[76:79], a[4:7]
    v_perm_b32 v9, v29, v25, s44
    v_perm_b32 v10, v37, v33, s44
    v_mfma_f32_16x16x32_bf16 v[212:215], v[12:15], a[72:75], v[212:215]
    v_perm_b32 v11, v45, v41, s44
    v_mfma_f32_16x16x32_bf16 v[180:183], v[12:15], a[68:71], v[180:183]
    v_mfma_f32_16x16x32_bf16 v[148:151], v[12:15], a[64:67], v[148:151]
    v_mfma_f32_16x16x32_bf16 v[152:155], v[8:11], a[64:67], v[152:155]
    buffer_load_dwordx4 v[104:107], v1, s[20:23], s42 offen
    buffer_load_dwordx4 v[108:111], v1, s[20:23], s43 offen
    v_mfma_f32_16x16x32_bf16 v[184:187], v[8:11], a[68:71], v[184:187]
    v_perm_b32 v12, v21, v17, s45
    v_perm_b32 v13, v29, v25, s45
    v_mfma_f32_16x16x32_bf16 v[216:219], v[8:11], a[72:75], v[216:219]
    v_perm_b32 v14, v37, v33, s45
    v_perm_b32 v15, v45, v41, s45
    v_mfma_f32_16x16x32_bf16 a[8:11], v[8:11], a[76:79], a[8:11]
    v_xor_b32 v2, 64, v2
    v_add_u32 v1, 0x40000, v1
    v_mfma_f32_16x16x32_bf16 a[40:43], v[8:11], a[80:83], a[40:43]
    ds_read_b128 a[84:87], v2 offset:20480
    v_and_b32 v1, 0x3fffff, v1
    v_mfma_f32_16x16x32_bf16 a[44:47], v[12:15], a[80:83], a[44:47]
    ds_read_b128 a[88:91], v2 offset:24576
    buffer_load_dwordx4 v[112:115], v1, s[20:23], 0 offen
    v_mfma_f32_16x16x32_bf16 a[12:15], v[12:15], a[76:79], a[12:15]
    v_perm_b32 v8, v22, v18, s44
    v_perm_b32 v9, v30, v26, s44
    v_mfma_f32_16x16x32_bf16 v[220:223], v[12:15], a[72:75], v[220:223]
    v_perm_b32 v10, v38, v34, s44
    v_perm_b32 v11, v46, v42, s44
    v_mfma_f32_16x16x32_bf16 v[188:191], v[12:15], a[68:71], v[188:191]
    v_mfma_f32_16x16x32_bf16 v[156:159], v[12:15], a[64:67], v[156:159]
    v_mfma_f32_16x16x32_bf16 v[160:163], v[8:11], a[64:67], v[160:163]
    ds_read_b128 a[92:95], v2 offset:28672
    buffer_load_dwordx4 v[116:119], v1, s[20:23], s37 offen
    v_mfma_f32_16x16x32_bf16 v[192:195], v[8:11], a[68:71], v[192:195]
    v_perm_b32 v12, v22, v18, s45
    v_perm_b32 v13, v30, v26, s45
    v_mfma_f32_16x16x32_bf16 v[224:227], v[8:11], a[72:75], v[224:227]
    v_perm_b32 v14, v38, v34, s45
    v_perm_b32 v15, v46, v42, s45
    v_mfma_f32_16x16x32_bf16 a[16:19], v[8:11], a[76:79], a[16:19]
    v_mfma_f32_16x16x32_bf16 a[48:51], v[8:11], a[80:83], a[48:51]
    v_mfma_f32_16x16x32_bf16 a[52:55], v[12:15], a[80:83], a[52:55]
    ds_read_b128 a[96:99], v2 offset:32768
    buffer_load_dwordx4 v[120:123], v1, s[20:23], s38 offen
    v_mfma_f32_16x16x32_bf16 a[20:23], v[12:15], a[76:79], a[20:23]
    buffer_load_dwordx4 v[124:127], v1, s[20:23], s39 offen
    v_perm_b32 v8, v23, v19, s44
    v_mfma_f32_16x16x32_bf16 v[228:231], v[12:15], a[72:75], v[228:231]
    v_perm_b32 v9, v31, v27, s44
    v_perm_b32 v10, v39, v35, s44
    v_mfma_f32_16x16x32_bf16 v[196:199], v[12:15], a[68:71], v[196:199]
    v_perm_b32 v11, v47, v43, s44
    v_mfma_f32_16x16x32_bf16 v[164:167], v[12:15], a[64:67], v[164:167]
    s_nop 0
    v_mfma_f32_16x16x32_bf16 v[168:171], v[8:11], a[64:67], v[168:171]
    ds_read_b128 a[100:103], v2 offset:36864
    buffer_load_dwordx4 v[128:131], v1, s[20:23], s40 offen
    v_mfma_f32_16x16x32_bf16 v[200:203], v[8:11], a[68:71], v[200:203]
    v_perm_b32 v12, v23, v19, s45
    v_perm_b32 v13, v31, v27, s45
    v_mfma_f32_16x16x32_bf16 v[232:235], v[8:11], a[72:75], v[232:235]
    v_perm_b32 v14, v39, v35, s45
    v_perm_b32 v15, v47, v43, s45
    v_mfma_f32_16x16x32_bf16 a[24:27], v[8:11], a[76:79], a[24:27]
    v_mfma_f32_16x16x32_bf16 a[56:59], v[8:11], a[80:83], a[56:59]
    v_mfma_f32_16x16x32_bf16 a[60:63], v[12:15], a[80:83], a[60:63]
    buffer_load_dwordx4 v[132:135], v1, s[20:23], s41 offen
    s_waitcnt vmcnt(16)
    v_perm_b32 v8, v52, v48, s44
    v_mfma_f32_16x16x32_bf16 a[28:31], v[12:15], a[76:79], a[28:31]
    v_perm_b32 v9, v60, v56, s44
    v_perm_b32 v10, v68, v64, s44
    v_mfma_f32_16x16x32_bf16 v[236:239], v[12:15], a[72:75], v[236:239]
    v_perm_b32 v11, v76, v72, s44
    v_mfma_f32_16x16x32_bf16 v[204:207], v[12:15], a[68:71], v[204:207]
    v_mfma_f32_16x16x32_bf16 v[172:175], v[12:15], a[64:67], v[172:175]
    s_waitcnt lgkmcnt(0)
    v_mfma_f32_16x16x32_bf16 v[144:147], v[8:11], a[84:87], v[144:147]
    buffer_load_dwordx4 v[136:139], v1, s[20:23], s42 offen
    buffer_load_dwordx4 v[140:143], v1, s[20:23], s43 offen
    v_mfma_f32_16x16x32_bf16 v[176:179], v[8:11], a[88:91], v[176:179]
    v_perm_b32 v12, v52, v48, s45
    v_perm_b32 v13, v60, v56, s45
    v_mfma_f32_16x16x32_bf16 v[208:211], v[8:11], a[92:95], v[208:211]
    v_perm_b32 v14, v68, v64, s45
    v_perm_b32 v15, v76, v72, s45
    v_mfma_f32_16x16x32_bf16 a[0:3], v[8:11], a[96:99], a[0:3]
    v_add_u32 v1, 0x40000, v1
    v_and_b32 v1, 0x3fffff, v1
    v_mfma_f32_16x16x32_bf16 a[32:35], v[8:11], a[100:103], a[32:35]
    v_mfma_f32_16x16x32_bf16 a[36:39], v[12:15], a[100:103], a[36:39]
    buffer_load_dwordx4 v[16:19], v1, s[20:23], 0 offen
    v_perm_b32 v8, v53, v49, s44
    v_mfma_f32_16x16x32_bf16 a[4:7], v[12:15], a[96:99], a[4:7]
    v_perm_b32 v9, v61, v57, s44
    v_perm_b32 v10, v69, v65, s44
    v_mfma_f32_16x16x32_bf16 v[212:215], v[12:15], a[92:95], v[212:215]
    v_perm_b32 v11, v77, v73, s44
    v_mfma_f32_16x16x32_bf16 v[180:183], v[12:15], a[88:91], v[180:183]
    v_mfma_f32_16x16x32_bf16 v[148:151], v[12:15], a[84:87], v[148:151]
    v_mfma_f32_16x16x32_bf16 v[152:155], v[8:11], a[84:87], v[152:155]
    buffer_load_dwordx4 v[20:23], v1, s[20:23], s37 offen
    v_perm_b32 v12, v53, v49, s45
    v_mfma_f32_16x16x32_bf16 v[184:187], v[8:11], a[88:91], v[184:187]
    v_perm_b32 v13, v61, v57, s45
    v_perm_b32 v14, v69, v65, s45
    v_mfma_f32_16x16x32_bf16 v[216:219], v[8:11], a[92:95], v[216:219]
    v_perm_b32 v15, v77, v73, s45
    v_xor_b32 v2, 192, v2
    v_mfma_f32_16x16x32_bf16 a[8:11], v[8:11], a[96:99], a[8:11]
    ds_read_b128 a[64:67], v2 offset:20480
    v_mfma_f32_16x16x32_bf16 a[40:43], v[8:11], a[100:103], a[40:43]
    v_mfma_f32_16x16x32_bf16 a[44:47], v[12:15], a[100:103], a[44:47]
    ds_read_b128 a[68:71], v2 offset:24576
    buffer_load_dwordx4 v[24:27], v1, s[20:23], s38 offen
    v_mfma_f32_16x16x32_bf16 a[12:15], v[12:15], a[96:99], a[12:15]
    v_perm_b32 v8, v54, v50, s44
    v_perm_b32 v9, v62, v58, s44
    v_mfma_f32_16x16x32_bf16 v[220:223], v[12:15], a[92:95], v[220:223]
    v_perm_b32 v10, v70, v66, s44
    v_perm_b32 v11, v78, v74, s44
    v_mfma_f32_16x16x32_bf16 v[188:191], v[12:15], a[88:91], v[188:191]
    v_mfma_f32_16x16x32_bf16 v[156:159], v[12:15], a[84:87], v[156:159]
    v_mfma_f32_16x16x32_bf16 v[160:163], v[8:11], a[84:87], v[160:163]
    ds_read_b128 a[72:75], v2 offset:28672
    buffer_load_dwordx4 v[28:31], v1, s[20:23], s39 offen
    v_mfma_f32_16x16x32_bf16 v[192:195], v[8:11], a[88:91], v[192:195]
    buffer_load_dwordx4 v[32:35], v1, s[20:23], s40 offen
    v_perm_b32 v12, v54, v50, s45
    v_mfma_f32_16x16x32_bf16 v[224:227], v[8:11], a[92:95], v[224:227]
    v_perm_b32 v13, v62, v58, s45
    v_perm_b32 v14, v70, v66, s45
    v_mfma_f32_16x16x32_bf16 a[16:19], v[8:11], a[96:99], a[16:19]
    v_perm_b32 v15, v78, v74, s45
    v_mfma_f32_16x16x32_bf16 a[48:51], v[8:11], a[100:103], a[48:51]
    s_nop 0
    v_mfma_f32_16x16x32_bf16 a[52:55], v[12:15], a[100:103], a[52:55]
    ds_read_b128 a[76:79], v2 offset:32768
    buffer_load_dwordx4 v[36:39], v1, s[20:23], s41 offen
    v_mfma_f32_16x16x32_bf16 a[20:23], v[12:15], a[96:99], a[20:23]
    v_perm_b32 v8, v55, v51, s44
    v_perm_b32 v9, v63, v59, s44
    v_mfma_f32_16x16x32_bf16 v[228:231], v[12:15], a[92:95], v[228:231]
    v_perm_b32 v10, v71, v67, s44
    v_perm_b32 v11, v79, v75, s44
    v_mfma_f32_16x16x32_bf16 v[196:199], v[12:15], a[88:91], v[196:199]
    v_mfma_f32_16x16x32_bf16 v[164:167], v[12:15], a[84:87], v[164:167]
    v_mfma_f32_16x16x32_bf16 v[168:171], v[8:11], a[84:87], v[168:171]
    ds_read_b128 a[80:83], v2 offset:36864
    buffer_load_dwordx4 v[40:43], v1, s[20:23], s42 offen
    v_mfma_f32_16x16x32_bf16 v[200:203], v[8:11], a[88:91], v[200:203]
    v_perm_b32 v12, v55, v51, s45
    v_perm_b32 v13, v63, v59, s45
    v_mfma_f32_16x16x32_bf16 v[232:235], v[8:11], a[92:95], v[232:235]
    v_perm_b32 v14, v71, v67, s45
    v_perm_b32 v15, v79, v75, s45
    v_mfma_f32_16x16x32_bf16 a[24:27], v[8:11], a[96:99], a[24:27]
    v_mfma_f32_16x16x32_bf16 a[56:59], v[8:11], a[100:103], a[56:59]
    v_mfma_f32_16x16x32_bf16 a[60:63], v[12:15], a[100:103], a[60:63]
    buffer_load_dwordx4 v[44:47], v1, s[20:23], s43 offen
    s_waitcnt vmcnt(16)
    v_perm_b32 v8, v84, v80, s44
    v_mfma_f32_16x16x32_bf16 a[28:31], v[12:15], a[96:99], a[28:31]
    v_perm_b32 v9, v92, v88, s44
    v_perm_b32 v10, v100, v96, s44
    v_mfma_f32_16x16x32_bf16 v[236:239], v[12:15], a[92:95], v[236:239]
    v_perm_b32 v11, v108, v104, s44
    v_add_u32 v1, 0x40000, v1
    v_mfma_f32_16x16x32_bf16 v[204:207], v[12:15], a[88:91], v[204:207]
    v_and_b32 v1, 0x3fffff, v1
    v_mfma_f32_16x16x32_bf16 v[172:175], v[12:15], a[84:87], v[172:175]
    s_waitcnt lgkmcnt(0)
    v_mfma_f32_16x16x32_bf16 v[144:147], v[8:11], a[64:67], v[144:147]
    s_lshl_b32 s3, s56, 3
    s_add_u32 s3, s3, s49
    v_mfma_f32_16x16x32_bf16 v[176:179], v[8:11], a[68:71], v[176:179]
    s_lshl_b32 s7, s47, 12
    s_add_u32 s3, s3, s7
    v_mfma_f32_16x16x32_bf16 v[208:211], v[8:11], a[72:75], v[208:211]
    s_bfe_u32 s7, s2, 0x20003
    s_cmp_eq_u32 s7, 0
    v_mfma_f32_16x16x32_bf16 a[0:3], v[8:11], a[76:79], a[0:3]
    s_cselect_b32 s7, 0, 0x1000
    v_perm_b32 v12, v84, v80, s45
    v_mfma_f32_16x16x32_bf16 a[32:35], v[8:11], a[80:83], a[32:35]
    v_perm_b32 v13, v92, v88, s45
    v_perm_b32 v14, v100, v96, s45
    v_perm_b32 v15, v108, v104, s45
    v_lshl_add_u32 v249, v0, 12, s3
    v_mov_b32 v248, 1
    buffer_store_byte v248, v249, s[52:55], s7 offen sc1
    s_bfe_u32 s7, s2, 0x20003
    s_cmp_eq_u32 s7, 1
    s_cselect_b32 s7, 0, 0x1000
    buffer_store_byte v248, v249, s[52:55], s7 offen sc1
    s_add_u32 m0, s4, 4096
    s_mov_b32 s7, 4096
    buffer_load_dwordx4 v7, s[12:15], s7 offen offset:3072 nt lds
    s_add_u32 m0, s4, 8192
    s_mov_b32 s7, 8192
    buffer_load_dwordx4 v4, s[12:15], s7 offen offset:0 nt lds
    buffer_load_dwordx4 v5, s[12:15], s7 offen offset:1024 nt lds
    buffer_load_dwordx4 v6, s[12:15], s7 offen offset:2048 nt lds
    buffer_load_dwordx4 v7, s[12:15], s7 offen offset:3072 nt lds
    s_add_u32 m0, s4, 12288
    s_mov_b32 s7, 12288
    buffer_load_dwordx4 v4, s[12:15], s7 offen offset:0 nt lds
    buffer_load_dwordx4 v5, s[12:15], s7 offen offset:1024 nt lds
    v_mfma_f32_16x16x32_bf16 a[36:39], v[12:15], a[80:83], a[36:39]
    v_perm_b32 v8, v85, v81, s44
    v_perm_b32 v9, v93, v89, s44
    v_mfma_f32_16x16x32_bf16 a[4:7], v[12:15], a[76:79], a[4:7]
    v_perm_b32 v10, v101, v97, s44
    v_perm_b32 v11, v109, v105, s44
    v_mfma_f32_16x16x32_bf16 v[212:215], v[12:15], a[72:75], v[212:215]
    v_mfma_f32_16x16x32_bf16 v[180:183], v[12:15], a[68:71], v[180:183]
    v_mfma_f32_16x16x32_bf16 v[148:151], v[12:15], a[64:67], v[148:151]
    v_mfma_f32_16x16x32_bf16 v[152:155], v[8:11], a[64:67], v[152:155]
    v_perm_b32 v12, v85, v81, s45
    v_perm_b32 v13, v93, v89, s45
    v_mfma_f32_16x16x32_bf16 v[184:187], v[8:11], a[68:71], v[184:187]
    v_perm_b32 v14, v101, v97, s45
    v_perm_b32 v15, v109, v105, s45
    v_mfma_f32_16x16x32_bf16 v[216:219], v[8:11], a[72:75], v[216:219]
    v_xor_b32 v2, 64, v2
    v_mfma_f32_16x16x32_bf16 a[8:11], v[8:11], a[76:79], a[8:11]
    ds_read_b128 a[84:87], v2 offset:20480
    v_mfma_f32_16x16x32_bf16 a[40:43], v[8:11], a[80:83], a[40:43]
    v_mfma_f32_16x16x32_bf16 a[44:47], v[12:15], a[80:83], a[44:47]
    ds_read_b128 a[88:91], v2 offset:24576
    v_perm_b32 v8, v86, v82, s44
    v_mfma_f32_16x16x32_bf16 a[12:15], v[12:15], a[76:79], a[12:15]
    v_perm_b32 v9, v94, v90, s44
    v_perm_b32 v10, v102, v98, s44
    v_mfma_f32_16x16x32_bf16 v[220:223], v[12:15], a[72:75], v[220:223]
    v_perm_b32 v11, v110, v106, s44
    v_mfma_f32_16x16x32_bf16 v[188:191], v[12:15], a[68:71], v[188:191]
    v_mfma_f32_16x16x32_bf16 v[156:159], v[12:15], a[64:67], v[156:159]
    v_mfma_f32_16x16x32_bf16 v[160:163], v[8:11], a[64:67], v[160:163]
    ds_read_b128 a[92:95], v2 offset:28672
    v_perm_b32 v12, v86, v82, s45
    v_mfma_f32_16x16x32_bf16 v[192:195], v[8:11], a[68:71], v[192:195]
    v_perm_b32 v13, v94, v90, s45
    v_perm_b32 v14, v102, v98, s45
    v_mfma_f32_16x16x32_bf16 v[224:227], v[8:11], a[72:75], v[224:227]
    v_perm_b32 v15, v110, v106, s45
    v_mfma_f32_16x16x32_bf16 a[16:19], v[8:11], a[76:79], a[16:19]
    v_mfma_f32_16x16x32_bf16 a[48:51], v[8:11], a[80:83], a[48:51]
    v_mfma_f32_16x16x32_bf16 a[52:55], v[12:15], a[80:83], a[52:55]
    ds_read_b128 a[96:99], v2 offset:32768
    v_perm_b32 v8, v87, v83, s44
    v_mfma_f32_16x16x32_bf16 a[20:23], v[12:15], a[76:79], a[20:23]
    v_perm_b32 v9, v95, v91, s44
    v_perm_b32 v10, v103, v99, s44
    v_mfma_f32_16x16x32_bf16 v[228:231], v[12:15], a[72:75], v[228:231]
    v_perm_b32 v11, v111, v107, s44
    v_mfma_f32_16x16x32_bf16 v[196:199], v[12:15], a[68:71], v[196:199]
    v_mfma_f32_16x16x32_bf16 v[164:167], v[12:15], a[64:67], v[164:167]
    v_mfma_f32_16x16x32_bf16 v[168:171], v[8:11], a[64:67], v[168:171]
    ds_read_b128 a[100:103], v2 offset:36864
    v_perm_b32 v12, v87, v83, s45
    v_mfma_f32_16x16x32_bf16 v[200:203], v[8:11], a[68:71], v[200:203]
    v_perm_b32 v13, v95, v91, s45
    v_perm_b32 v14, v103, v99, s45
    v_mfma_f32_16x16x32_bf16 v[232:235], v[8:11], a[72:75], v[232:235]
    v_perm_b32 v15, v111, v107, s45
    v_mfma_f32_16x16x32_bf16 a[24:27], v[8:11], a[76:79], a[24:27]
    v_mfma_f32_16x16x32_bf16 a[56:59], v[8:11], a[80:83], a[56:59]
    v_mfma_f32_16x16x32_bf16 a[60:63], v[12:15], a[80:83], a[60:63]
    s_waitcnt vmcnt(17)
    v_perm_b32 v8, v116, v112, s44
    v_perm_b32 v9, v124, v120, s44
    v_mfma_f32_16x16x32_bf16 a[28:31], v[12:15], a[76:79], a[28:31]
    v_perm_b32 v10, v132, v128, s44
    v_perm_b32 v11, v140, v136, s44
    v_mfma_f32_16x16x32_bf16 v[236:239], v[12:15], a[72:75], v[236:239]
    v_mfma_f32_16x16x32_bf16 v[204:207], v[12:15], a[68:71], v[204:207]
    v_mfma_f32_16x16x32_bf16 v[172:175], v[12:15], a[64:67], v[172:175]
    s_waitcnt lgkmcnt(0)
    v_mfma_f32_16x16x32_bf16 v[144:147], v[8:11], a[84:87], v[144:147]
    buffer_load_dwordx4 v[48:51], v1, s[20:23], 0 offen
    buffer_load_dwordx4 v[52:55], v1, s[20:23], s37 offen
    v_mfma_f32_16x16x32_bf16 v[176:179], v[8:11], a[88:91], v[176:179]
    s_add_u32 m0, s57, 61440
    v_perm_b32 v12, v116, v112, s45
    v_mfma_f32_16x16x32_bf16 v[208:211], v[8:11], a[92:95], v[208:211]
    v_perm_b32 v13, v124, v120, s45
    v_perm_b32 v14, v132, v128, s45
    v_mfma_f32_16x16x32_bf16 a[0:3], v[8:11], a[96:99], a[0:3]
    v_perm_b32 v15, v140, v136, s45
    v_add_u32 v253, 256, v253
    v_mfma_f32_16x16x32_bf16 a[32:35], v[8:11], a[100:103], a[32:35]
    v_and_b32 v254, 0x3ff, v253
    v_or_b32 v254, v254, v252
    s_nop 0
    buffer_load_dwordx4 v254, s[8:11], 0 offen  lds
    s_add_u32 m0, s57, 65536
    v_mfma_f32_16x16x32_bf16 a[36:39], v[12:15], a[100:103], a[36:39]
    buffer_load_dwordx4 v[56:59], v1, s[20:23], s38 offen
    v_perm_b32 v8, v117, v113, s44
    v_mfma_f32_16x16x32_bf16 a[4:7], v[12:15], a[96:99], a[4:7]
    v_perm_b32 v9, v125, v121, s44
    v_perm_b32 v10, v133, v129, s44
    v_mfma_f32_16x16x32_bf16 v[212:215], v[12:15], a[92:95], v[212:215]
    v_perm_b32 v11, v141, v137, s44
    v_mfma_f32_16x16x32_bf16 v[180:183], v[12:15], a[88:91], v[180:183]
    v_mfma_f32_16x16x32_bf16 v[148:151], v[12:15], a[84:87], v[148:151]
    v_mfma_f32_16x16x32_bf16 v[152:155], v[8:11], a[84:87], v[152:155]
    s_barrier
    buffer_load_dwordx4 v[60:63], v1, s[20:23], s39 offen
    v_mfma_f32_16x16x32_bf16 v[184:187], v[8:11], a[88:91], v[184:187]
    buffer_load_dwordx4 v[64:67], v1, s[20:23], s40 offen
    buffer_load_dwordx4 v254, s[8:11], s38 offen  lds
    v_mfma_f32_16x16x32_bf16 v[216:219], v[8:11], a[92:95], v[216:219]
    s_add_u32 m0, s57, 69632
    v_perm_b32 v12, v117, v113, s45
    v_mfma_f32_16x16x32_bf16 a[8:11], v[8:11], a[96:99], a[8:11]
    v_perm_b32 v13, v125, v121, s45
    v_perm_b32 v14, v133, v129, s45
    v_mfma_f32_16x16x32_bf16 a[40:43], v[8:11], a[100:103], a[40:43]
    v_perm_b32 v15, v141, v137, s45
    v_xor_b32 v2, 192, v2
    v_add_u32 v2, 40960, v2
    ds_read_b128 a[64:67], v2 offset:0
    v_mfma_f32_16x16x32_bf16 a[44:47], v[12:15], a[100:103], a[44:47]
    ds_read_b128 a[68:71], v2 offset:4096
    buffer_load_dwordx4 v[68:71], v1, s[20:23], s41 offen
    v_mfma_f32_16x16x32_bf16 a[12:15], v[12:15], a[96:99], a[12:15]
    v_perm_b32 v8, v118, v114, s44
    v_perm_b32 v9, v126, v122, s44
    v_mfma_f32_16x16x32_bf16 v[220:223], v[12:15], a[92:95], v[220:223]
    v_perm_b32 v10, v134, v130, s44
    v_perm_b32 v11, v142, v138, s44
    v_mfma_f32_16x16x32_bf16 v[188:191], v[12:15], a[88:91], v[188:191]
    v_mfma_f32_16x16x32_bf16 v[156:159], v[12:15], a[84:87], v[156:159]
    v_mfma_f32_16x16x32_bf16 v[160:163], v[8:11], a[84:87], v[160:163]
    ds_read_b128 a[72:75], v2 offset:8192
    buffer_load_dwordx4 v[72:75], v1, s[20:23], s42 offen
    v_mfma_f32_16x16x32_bf16 v[192:195], v[8:11], a[88:91], v[192:195]
    buffer_load_dwordx4 v[76:79], v1, s[20:23], s43 offen
    buffer_load_dwordx4 v254, s[8:11], s40 offen  lds
    v_mfma_f32_16x16x32_bf16 v[224:227], v[8:11], a[92:95], v[224:227]
    s_add_u32 m0, s57, 73728
    v_perm_b32 v12, v118, v114, s45
    v_mfma_f32_16x16x32_bf16 a[16:19], v[8:11], a[96:99], a[16:19]
    v_perm_b32 v13, v126, v122, s45
    v_perm_b32 v14, v134, v130, s45
    v_mfma_f32_16x16x32_bf16 a[48:51], v[8:11], a[100:103], a[48:51]
    v_perm_b32 v15, v142, v138, s45
    v_add_u32 v1, 0x40000, v1
    v_and_b32 v1, 0x3fffff, v1
    v_mfma_f32_16x16x32_bf16 a[52:55], v[12:15], a[100:103], a[52:55]
    ds_read_b128 a[76:79], v2 offset:12288
    buffer_load_dwordx4 v[80:83], v1, s[20:23], 0 offen
    v_mfma_f32_16x16x32_bf16 a[20:23], v[12:15], a[96:99], a[20:23]
    buffer_load_dwordx4 v254, s[8:11], s42 offen  lds
    s_add_u32 m0, s57, 77824
    v_mfma_f32_16x16x32_bf16 v[228:231], v[12:15], a[92:95], v[228:231]
    v_perm_b32 v8, v119, v115, s44
    v_perm_b32 v9, v127, v123, s44
    v_mfma_f32_16x16x32_bf16 v[196:199], v[12:15], a[88:91], v[196:199]
    v_perm_b32 v10, v135, v131, s44
    v_perm_b32 v11, v143, v139, s44
    v_mfma_f32_16x16x32_bf16 v[164:167], v[12:15], a[84:87], v[164:167]
    s_nop 0
    v_mfma_f32_16x16x32_bf16 v[168:171], v[8:11], a[84:87], v[168:171]
    ds_read_b128 a[80:83], v2 offset:16384
    buffer_load_dwordx4 v[84:87], v1, s[20:23], s37 offen
    v_mfma_f32_16x16x32_bf16 v[200:203], v[8:11], a[88:91], v[200:203]
    buffer_load_dwordx4 v[88:91], v1, s[20:23], s38 offen
    v_perm_b32 v12, v119, v115, s45
    v_mfma_f32_16x16x32_bf16 v[232:235], v[8:11], a[92:95], v[232:235]
    v_perm_b32 v13, v127, v123, s45
    v_perm_b32 v14, v135, v131, s45
    v_mfma_f32_16x16x32_bf16 a[24:27], v[8:11], a[96:99], a[24:27]
    v_perm_b32 v15, v143, v139, s45
    v_mfma_f32_16x16x32_bf16 a[56:59], v[8:11], a[100:103], a[56:59]
    s_nop 0
    v_mfma_f32_16x16x32_bf16 a[60:63], v[12:15], a[100:103], a[60:63]
    buffer_load_dwordx4 v[92:95], v1, s[20:23], s39 offen
    buffer_load_dwordx4 v254, s[8:11], s58 offen  lds
    v_mfma_f32_16x16x32_bf16 a[28:31], v[12:15], a[96:99], a[28:31]
    s_waitcnt vmcnt(26)
    v_perm_b32 v8, v20, v16, s44
    v_perm_b32 v9, v28, v24, s44
    v_mfma_f32_16x16x32_bf16 v[236:239], v[12:15], a[92:95], v[236:239]
    v_perm_b32 v10, v36, v32, s44
    v_perm_b32 v11, v44, v40, s44
    v_mfma_f32_16x16x32_bf16 v[204:207], v[12:15], a[88:91], v[204:207]
    v_mfma_f32_16x16x32_bf16 v[172:175], v[12:15], a[84:87], v[172:175]
    s_waitcnt lgkmcnt(0)
    v_mfma_f32_16x16x32_bf16 v[144:147], v[8:11], a[64:67], v[144:147]
    buffer_load_dwordx4 v[96:99], v1, s[20:23], s40 offen
    buffer_load_dwordx4 v[100:103], v1, s[20:23], s41 offen
    v_mfma_f32_16x16x32_bf16 v[176:179], v[8:11], a[68:71], v[176:179]
    v_perm_b32 v12, v20, v16, s45
    v_perm_b32 v13, v28, v24, s45
    v_mfma_f32_16x16x32_bf16 v[208:211], v[8:11], a[72:75], v[208:211]
    v_perm_b32 v14, v36, v32, s45
    v_perm_b32 v15, v44, v40, s45
    v_mfma_f32_16x16x32_bf16 a[0:3], v[8:11], a[76:79], a[0:3]
    v_mfma_f32_16x16x32_bf16 a[32:35], v[8:11], a[80:83], a[32:35]
    v_mfma_f32_16x16x32_bf16 a[36:39], v[12:15], a[80:83], a[36:39]
    buffer_load_dwordx4 v[104:107], v1, s[20:23], s42 offen
    v_perm_b32 v8, v21, v17, s44
    v_mfma_f32_16x16x32_bf16 a[4:7], v[12:15], a[76:79], a[4:7]
    v_perm_b32 v9, v29, v25, s44
    v_perm_b32 v10, v37, v33, s44
    v_mfma_f32_16x16x32_bf16 v[212:215], v[12:15], a[72:75], v[212:215]
    v_perm_b32 v11, v45, v41, s44
    v_mfma_f32_16x16x32_bf16 v[180:183], v[12:15], a[68:71], v[180:183]
    v_mfma_f32_16x16x32_bf16 v[148:151], v[12:15], a[64:67], v[148:151]
    v_mfma_f32_16x16x32_bf16 v[152:155], v[8:11], a[64:67], v[152:155]
    buffer_load_dwordx4 v[108:111], v1, s[20:23], s43 offen
    v_perm_b32 v12, v21, v17, s45
    v_mfma_f32_16x16x32_bf16 v[184:187], v[8:11], a[68:71], v[184:187]
    v_perm_b32 v13, v29, v25, s45
    v_perm_b32 v14, v37, v33, s45
    v_mfma_f32_16x16x32_bf16 v[216:219], v[8:11], a[72:75], v[216:219]
    v_perm_b32 v15, v45, v41, s45
    v_xor_b32 v2, 64, v2
    v_mfma_f32_16x16x32_bf16 a[8:11], v[8:11], a[76:79], a[8:11]
    ds_read_b128 a[84:87], v2 offset:0
    v_add_u32 v1, 0x40000, v1
    v_mfma_f32_16x16x32_bf16 a[40:43], v[8:11], a[80:83], a[40:43]
    v_and_b32 v1, 0x3fffff, v1
    buffer_load_dwordx4 v[112:115], v1, s[20:23], 0 offen
    v_mfma_f32_16x16x32_bf16 a[44:47], v[12:15], a[80:83], a[44:47]
    ds_read_b128 a[88:91], v2 offset:4096
    buffer_load_dwordx4 v[116:119], v1, s[20:23], s37 offen
    v_mfma_f32_16x16x32_bf16 a[12:15], v[12:15], a[76:79], a[12:15]
    v_perm_b32 v8, v22, v18, s44
    v_perm_b32 v9, v30, v26, s44
    v_mfma_f32_16x16x32_bf16 v[220:223], v[12:15], a[72:75], v[220:223]
    v_perm_b32 v10, v38, v34, s44
    v_perm_b32 v11, v46, v42, s44
    v_mfma_f32_16x16x32_bf16 v[188:191], v[12:15], a[68:71], v[188:191]
    v_mfma_f32_16x16x32_bf16 v[156:159], v[12:15], a[64:67], v[156:159]
    v_mfma_f32_16x16x32_bf16 v[160:163], v[8:11], a[64:67], v[160:163]
    ds_read_b128 a[92:95], v2 offset:8192
    buffer_load_dwordx4 v[120:123], v1, s[20:23], s38 offen
    v_mfma_f32_16x16x32_bf16 v[192:195], v[8:11], a[68:71], v[192:195]
    buffer_load_dwordx4 v[124:127], v1, s[20:23], s39 offen
    v_perm_b32 v12, v22, v18, s45
    v_mfma_f32_16x16x32_bf16 v[224:227], v[8:11], a[72:75], v[224:227]
    v_perm_b32 v13, v30, v26, s45
    v_perm_b32 v14, v38, v34, s45
    v_mfma_f32_16x16x32_bf16 a[16:19], v[8:11], a[76:79], a[16:19]
    v_perm_b32 v15, v46, v42, s45
    v_mfma_f32_16x16x32_bf16 a[48:51], v[8:11], a[80:83], a[48:51]
    s_nop 0
    v_mfma_f32_16x16x32_bf16 a[52:55], v[12:15], a[80:83], a[52:55]
    ds_read_b128 a[96:99], v2 offset:12288
    buffer_load_dwordx4 v[128:131], v1, s[20:23], s40 offen
    v_mfma_f32_16x16x32_bf16 a[20:23], v[12:15], a[76:79], a[20:23]
    v_perm_b32 v8, v23, v19, s44
    v_perm_b32 v9, v31, v27, s44
    v_mfma_f32_16x16x32_bf16 v[228:231], v[12:15], a[72:75], v[228:231]
    v_perm_b32 v10, v39, v35, s44
    v_perm_b32 v11, v47, v43, s44
    v_mfma_f32_16x16x32_bf16 v[196:199], v[12:15], a[68:71], v[196:199]
    v_mfma_f32_16x16x32_bf16 v[164:167], v[12:15], a[64:67], v[164:167]
    v_mfma_f32_16x16x32_bf16 v[168:171], v[8:11], a[64:67], v[168:171]
    ds_read_b128 a[100:103], v2 offset:16384
    buffer_load_dwordx4 v[132:135], v1, s[20:23], s41 offen
    v_mfma_f32_16x16x32_bf16 v[200:203], v[8:11], a[68:71], v[200:203]
    buffer_load_dwordx4 v[136:139], v1, s[20:23], s42 offen
    v_perm_b32 v12, v23, v19, s45
    v_mfma_f32_16x16x32_bf16 v[232:235], v[8:11], a[72:75], v[232:235]
    v_perm_b32 v13, v31, v27, s45
    v_perm_b32 v14, v39, v35, s45
    v_mfma_f32_16x16x32_bf16 a[24:27], v[8:11], a[76:79], a[24:27]
    v_perm_b32 v15, v47, v43, s45
    v_mfma_f32_16x16x32_bf16 a[56:59], v[8:11], a[80:83], a[56:59]
    s_nop 0
    v_mfma_f32_16x16x32_bf16 a[60:63], v[12:15], a[80:83], a[60:63]
    buffer_load_dwordx4 v[140:143], v1, s[20:23], s43 offen
    s_waitcnt vmcnt(19)
    v_perm_b32 v8, v52, v48, s44
    v_mfma_f32_16x16x32_bf16 a[28:31], v[12:15], a[76:79], a[28:31]
    v_perm_b32 v9, v60, v56, s44
    v_perm_b32 v10, v68, v64, s44
    v_mfma_f32_16x16x32_bf16 v[236:239], v[12:15], a[72:75], v[236:239]
    v_perm_b32 v11, v76, v72, s44
    v_add_u32 v1, 0x40000, v1
    v_mfma_f32_16x16x32_bf16 v[204:207], v[12:15], a[68:71], v[204:207]
    v_and_b32 v1, 0x3fffff, v1
    v_mfma_f32_16x16x32_bf16 v[172:175], v[12:15], a[64:67], v[172:175]
    s_waitcnt lgkmcnt(0)
    v_mfma_f32_16x16x32_bf16 v[144:147], v[8:11], a[84:87], v[144:147]
    s_bfe_u32 s7, s2, 0x20003
    s_cmp_eq_u32 s7, 2
    v_mfma_f32_16x16x32_bf16 v[176:179], v[8:11], a[88:91], v[176:179]
    s_cselect_b32 s7, 0, 0x1000
    buffer_store_byte v248, v249, s[52:55], s7 offen sc1
    v_mfma_f32_16x16x32_bf16 v[208:211], v[8:11], a[92:95], v[208:211]
    s_bfe_u32 s7, s2, 0x20003
    s_cmp_eq_u32 s7, 3
    v_mfma_f32_16x16x32_bf16 a[0:3], v[8:11], a[96:99], a[0:3]
    s_cselect_b32 s7, 0, 0x1000
    buffer_store_byte v248, v249, s[52:55], s7 offen sc1
    v_mfma_f32_16x16x32_bf16 a[32:35], v[8:11], a[100:103], a[32:35]
    s_add_u32 m0, s4, 12288
    s_mov_b32 s7, 12288
    v_perm_b32 v12, v52, v48, s45
    v_perm_b32 v13, v60, v56, s45
    v_perm_b32 v14, v68, v64, s45
    v_perm_b32 v15, v76, v72, s45
    buffer_load_dwordx4 v6, s[12:15], s7 offen offset:2048 nt lds
    buffer_load_dwordx4 v7, s[12:15], s7 offen offset:3072 nt lds
    s_add_u32 m0, s4, 16384
    s_mov_b32 s7, 16384
    buffer_load_dwordx4 v4, s[12:15], s7 offen offset:0 nt lds
    buffer_load_dwordx4 v5, s[12:15], s7 offen offset:1024 nt lds
    buffer_load_dwordx4 v6, s[12:15], s7 offen offset:2048 nt lds
    buffer_load_dwordx4 v7, s[12:15], s7 offen offset:3072 nt lds
    v_mfma_f32_16x16x32_bf16 a[36:39], v[12:15], a[100:103], a[36:39]
    v_perm_b32 v8, v53, v49, s44
    v_perm_b32 v9, v61, v57, s44
    v_mfma_f32_16x16x32_bf16 a[4:7], v[12:15], a[96:99], a[4:7]
    v_perm_b32 v10, v69, v65, s44
    v_perm_b32 v11, v77, v73, s44
    v_mfma_f32_16x16x32_bf16 v[212:215], v[12:15], a[92:95], v[212:215]
    v_mfma_f32_16x16x32_bf16 v[180:183], v[12:15], a[88:91], v[180:183]
    v_mfma_f32_16x16x32_bf16 v[148:151], v[12:15], a[84:87], v[148:151]
    v_mfma_f32_16x16x32_bf16 v[152:155], v[8:11], a[84:87], v[152:155]
    v_perm_b32 v12, v53, v49, s45
    v_perm_b32 v13, v61, v57, s45
    v_mfma_f32_16x16x32_bf16 v[184:187], v[8:11], a[88:91], v[184:187]
    v_perm_b32 v14, v69, v65, s45
    v_perm_b32 v15, v77, v73, s45
    v_mfma_f32_16x16x32_bf16 v[216:219], v[8:11], a[92:95], v[216:219]
    v_xor_b32 v2, 192, v2
    v_mfma_f32_16x16x32_bf16 a[8:11], v[8:11], a[96:99], a[8:11]
    ds_read_b128 a[64:67], v2 offset:0
    v_mfma_f32_16x16x32_bf16 a[40:43], v[8:11], a[100:103], a[40:43]
    v_mfma_f32_16x16x32_bf16 a[44:47], v[12:15], a[100:103], a[44:47]
    ds_read_b128 a[68:71], v2 offset:4096
    v_perm_b32 v8, v54, v50, s44
    v_mfma_f32_16x16x32_bf16 a[12:15], v[12:15], a[96:99], a[12:15]
    v_perm_b32 v9, v62, v58, s44
    v_perm_b32 v10, v70, v66, s44
    v_mfma_f32_16x16x32_bf16 v[220:223], v[12:15], a[92:95], v[220:223]
    v_perm_b32 v11, v78, v74, s44
    v_mfma_f32_16x16x32_bf16 v[188:191], v[12:15], a[88:91], v[188:191]
    v_mfma_f32_16x16x32_bf16 v[156:159], v[12:15], a[84:87], v[156:159]
    v_mfma_f32_16x16x32_bf16 v[160:163], v[8:11], a[84:87], v[160:163]
    ds_read_b128 a[72:75], v2 offset:8192
    v_perm_b32 v12, v54, v50, s45
    v_mfma_f32_16x16x32_bf16 v[192:195], v[8:11], a[88:91], v[192:195]
    v_perm_b32 v13, v62, v58, s45
    v_perm_b32 v14, v70, v66, s45
    v_mfma_f32_16x16x32_bf16 v[224:227], v[8:11], a[92:95], v[224:227]
    v_perm_b32 v15, v78, v74, s45
    v_mfma_f32_16x16x32_bf16 a[16:19], v[8:11], a[96:99], a[16:19]
    v_mfma_f32_16x16x32_bf16 a[48:51], v[8:11], a[100:103], a[48:51]
    v_mfma_f32_16x16x32_bf16 a[52:55], v[12:15], a[100:103], a[52:55]
    ds_read_b128 a[76:79], v2 offset:12288
    v_perm_b32 v8, v55, v51, s44
    v_mfma_f32_16x16x32_bf16 a[20:23], v[12:15], a[96:99], a[20:23]
    v_perm_b32 v9, v63, v59, s44
    v_perm_b32 v10, v71, v67, s44
    v_mfma_f32_16x16x32_bf16 v[228:231], v[12:15], a[92:95], v[228:231]
    v_perm_b32 v11, v79, v75, s44
    v_mfma_f32_16x16x32_bf16 v[196:199], v[12:15], a[88:91], v[196:199]
    v_mfma_f32_16x16x32_bf16 v[164:167], v[12:15], a[84:87], v[164:167]
    v_mfma_f32_16x16x32_bf16 v[168:171], v[8:11], a[84:87], v[168:171]
    ds_read_b128 a[80:83], v2 offset:16384
    v_perm_b32 v12, v55, v51, s45
    v_mfma_f32_16x16x32_bf16 v[200:203], v[8:11], a[88:91], v[200:203]
    v_perm_b32 v13, v63, v59, s45
    v_perm_b32 v14, v71, v67, s45
    v_mfma_f32_16x16x32_bf16 v[232:235], v[8:11], a[92:95], v[232:235]
    v_perm_b32 v15, v79, v75, s45
    v_mfma_f32_16x16x32_bf16 a[24:27], v[8:11], a[96:99], a[24:27]
    v_mfma_f32_16x16x32_bf16 a[56:59], v[8:11], a[100:103], a[56:59]
    v_mfma_f32_16x16x32_bf16 a[60:63], v[12:15], a[100:103], a[60:63]
    s_waitcnt vmcnt(16)
    v_perm_b32 v8, v84, v80, s44
    v_perm_b32 v9, v92, v88, s44
    v_mfma_f32_16x16x32_bf16 a[28:31], v[12:15], a[96:99], a[28:31]
    v_perm_b32 v10, v100, v96, s44
    v_perm_b32 v11, v108, v104, s44
    v_mfma_f32_16x16x32_bf16 v[236:239], v[12:15], a[92:95], v[236:239]
    v_mfma_f32_16x16x32_bf16 v[204:207], v[12:15], a[88:91], v[204:207]
    v_mfma_f32_16x16x32_bf16 v[172:175], v[12:15], a[84:87], v[172:175]
    s_waitcnt lgkmcnt(0)
    v_mfma_f32_16x16x32_bf16 v[144:147], v[8:11], a[64:67], v[144:147]
    buffer_load_dwordx4 v[16:19], v1, s[20:23], 0 offen
    buffer_load_dwordx4 v[20:23], v1, s[20:23], s37 offen
    v_mfma_f32_16x16x32_bf16 v[176:179], v[8:11], a[68:71], v[176:179]
    v_perm_b32 v12, v84, v80, s45
    v_perm_b32 v13, v92, v88, s45
    v_mfma_f32_16x16x32_bf16 v[208:211], v[8:11], a[72:75], v[208:211]
    v_perm_b32 v14, v100, v96, s45
    v_perm_b32 v15, v108, v104, s45
    v_mfma_f32_16x16x32_bf16 a[0:3], v[8:11], a[76:79], a[0:3]
    v_lshrrev_b32 v7, 4, v0
    v_lshlrev_b32 v7, 1, v7
    v_mfma_f32_16x16x32_bf16 a[32:35], v[8:11], a[80:83], a[32:35]
    v_and_b32 v3, 7, v0
    v_xor_b32 v3, v3, v7
    v_lshlrev_b32 v3, 4, v3
    v_lshrrev_b32 v7, 3, v0
    v_mfma_f32_16x16x32_bf16 a[36:39], v[12:15], a[80:83], a[36:39]
    buffer_load_dwordx4 v[24:27], v1, s[20:23], s38 offen
    s_and_b32 s51, s48, 7
    v_mfma_f32_16x16x32_bf16 a[4:7], v[12:15], a[76:79], a[4:7]
    s_lshl_b32 s51, s51, 1
    s_lshl_b32 s3, s47, 8
    v_mfma_f32_16x16x32_bf16 v[212:215], v[12:15], a[72:75], v[212:215]
    v_perm_b32 v8, v85, v81, s44
    v_perm_b32 v9, v93, v89, s44
    v_mfma_f32_16x16x32_bf16 v[180:183], v[12:15], a[68:71], v[180:183]
    v_perm_b32 v10, v101, v97, s44
    v_perm_b32 v11, v109, v105, s44
    v_mfma_f32_16x16x32_bf16 v[148:151], v[12:15], a[64:67], v[148:151]
    v_lshl_add_u32 v3, v7, 10, v3
    v_mfma_f32_16x16x32_bf16 v[152:155], v[8:11], a[64:67], v[152:155]
    buffer_load_dwordx4 v[28:31], v1, s[20:23], s39 offen
    buffer_load_dwordx4 v[32:35], v1, s[20:23], s40 offen
    v_mfma_f32_16x16x32_bf16 v[184:187], v[8:11], a[68:71], v[184:187]
    s_lshl_b32 s5, s51, 15
    s_add_u32 s3, s3, s5
    v_mfma_f32_16x16x32_bf16 v[216:219], v[8:11], a[72:75], v[216:219]
    s_lshr_b32 s5, s48, 3
    s_lshl_b32 s5, s5, 7
    v_mfma_f32_16x16x32_bf16 a[8:11], v[8:11], a[76:79], a[8:11]
    v_perm_b32 v12, v85, v81, s45
    v_perm_b32 v13, v93, v89, s45
    v_mfma_f32_16x16x32_bf16 a[40:43], v[8:11], a[80:83], a[40:43]
    v_perm_b32 v14, v101, v97, s45
    v_perm_b32 v15, v109, v105, s45
    v_xor_b32 v2, 64, v2
    ds_read_b128 a[84:87], v2 offset:0
    v_mfma_f32_16x16x32_bf16 a[44:47], v[12:15], a[80:83], a[44:47]
    ds_read_b128 a[88:91], v2 offset:4096
    buffer_load_dwordx4 v[36:39], v1, s[20:23], s41 offen
    v_mfma_f32_16x16x32_bf16 a[12:15], v[12:15], a[76:79], a[12:15]
    s_add_u32 s3, s3, s5
    s_lshl_b32 s5, s47, 2
    v_mfma_f32_16x16x32_bf16 v[220:223], v[12:15], a[72:75], v[220:223]
    s_sub_u32 s5, s5, s51
    v_perm_b32 v8, v86, v82, s44
    v_mfma_f32_16x16x32_bf16 v[188:191], v[12:15], a[68:71], v[188:191]
    v_perm_b32 v9, v94, v90, s44
    v_perm_b32 v10, v102, v98, s44
    v_mfma_f32_16x16x32_bf16 v[156:159], v[12:15], a[64:67], v[156:159]
    v_perm_b32 v11, v110, v106, s44
    v_add_u32 v248, s3, v3
    s_nop 0
    v_mfma_f32_16x16x32_bf16 v[160:163], v[8:11], a[64:67], v[160:163]
    ds_read_b128 a[92:95], v2 offset:8192
    buffer_load_dwordx4 v[40:43], v1, s[20:23], s42 offen
    v_mfma_f32_16x16x32_bf16 v[192:195], v[8:11], a[68:71], v[192:195]
    buffer_load_dwordx4 v[44:47], v1, s[20:23], s43 offen
    s_add_u32 s3, s5, 0
    v_mfma_f32_16x16x32_bf16 v[224:227], v[8:11], a[72:75], v[224:227]
    s_and_b32 s3, s3, 15
    s_mul_i32 s3, s3, 5120
    v_mfma_f32_16x16x32_bf16 a[16:19], v[8:11], a[76:79], a[16:19]
    v_perm_b32 v12, v86, v82, s45
    v_perm_b32 v13, v94, v90, s45
    v_mfma_f32_16x16x32_bf16 a[48:51], v[8:11], a[80:83], a[48:51]
    v_perm_b32 v14, v102, v98, s45
    v_perm_b32 v15, v110, v106, s45
    v_add_u32 v1, 0x40000, v1
    v_and_b32 v1, 0x3fffff, v1
    v_lshl_add_u32 v249, v0, 4, s3
    v_mfma_f32_16x16x32_bf16 a[52:55], v[12:15], a[80:83], a[52:55]
    ds_read_b128 a[96:99], v2 offset:12288
    buffer_load_dwordx4 v[48:51], v1, s[20:23], 0 offen
    v_mfma_f32_16x16x32_bf16 a[20:23], v[12:15], a[76:79], a[20:23]
    s_add_u32 s3, s5, 1
    s_and_b32 s3, s3, 15
    v_mfma_f32_16x16x32_bf16 v[228:231], v[12:15], a[72:75], v[228:231]
    s_mul_i32 s3, s3, 5120
    v_perm_b32 v8, v87, v83, s44
    v_mfma_f32_16x16x32_bf16 v[196:199], v[12:15], a[68:71], v[196:199]
    v_perm_b32 v9, v95, v91, s44
    v_perm_b32 v10, v103, v99, s44
    v_mfma_f32_16x16x32_bf16 v[164:167], v[12:15], a[64:67], v[164:167]
    v_perm_b32 v11, v111, v107, s44
    v_lshl_add_u32 v6, v0, 4, s3
    s_nop 0
    v_mfma_f32_16x16x32_bf16 v[168:171], v[8:11], a[64:67], v[168:171]
    ds_read_b128 a[100:103], v2 offset:16384
    buffer_load_dwordx4 v[52:55], v1, s[20:23], s37 offen
    v_mfma_f32_16x16x32_bf16 v[200:203], v[8:11], a[68:71], v[200:203]
    buffer_load_dwordx4 v[56:59], v1, s[20:23], s38 offen
    s_add_u32 s3, s5, 2
    v_mfma_f32_16x16x32_bf16 v[232:235], v[8:11], a[72:75], v[232:235]
    s_and_b32 s3, s3, 15
    s_mul_i32 s3, s3, 5120
    v_mfma_f32_16x16x32_bf16 a[24:27], v[8:11], a[76:79], a[24:27]
    v_perm_b32 v12, v87, v83, s45
    v_perm_b32 v13, v95, v91, s45
    v_mfma_f32_16x16x32_bf16 a[56:59], v[8:11], a[80:83], a[56:59]
    v_perm_b32 v14, v103, v99, s45
    v_perm_b32 v15, v111, v107, s45
    v_lshl_add_u32 v7, v0, 4, s3
    s_nop 0
    v_mfma_f32_16x16x32_bf16 a[60:63], v[12:15], a[80:83], a[60:63]
    buffer_load_dwordx4 v[60:63], v1, s[20:23], s39 offen
    s_add_u32 s3, s5, 3
    v_mfma_f32_16x16x32_bf16 a[28:31], v[12:15], a[76:79], a[28:31]
    s_and_b32 s3, s3, 15
    s_mul_i32 s99, s3, 5120
    v_mfma_f32_16x16x32_bf16 v[236:239], v[12:15], a[72:75], v[236:239]
    s_lshl_b32 s98, s56, 3
    s_waitcnt vmcnt(20)
    v_perm_b32 v8, v116, v112, s44
    v_mfma_f32_16x16x32_bf16 v[204:207], v[12:15], a[68:71], v[204:207]
    v_perm_b32 v9, v124, v120, s44
    v_perm_b32 v10, v132, v128, s44
    v_mfma_f32_16x16x32_bf16 v[172:175], v[12:15], a[64:67], v[172:175]
    v_perm_b32 v11, v140, v136, s44
    s_waitcnt lgkmcnt(0)
    s_nop 0
    v_mfma_f32_16x16x32_bf16 v[144:147], v[8:11], a[84:87], v[144:147]
    buffer_load_dwordx4 v[64:67], v1, s[20:23], s40 offen
    buffer_load_dwordx4 v[68:71], v1, s[20:23], s41 offen
    v_mfma_f32_16x16x32_bf16 v[176:179], v[8:11], a[88:91], v[176:179]
    v_perm_b32 v12, v116, v112, s45
    v_perm_b32 v13, v124, v120, s45
    v_mfma_f32_16x16x32_bf16 v[208:211], v[8:11], a[92:95], v[208:211]
    v_perm_b32 v14, v132, v128, s45
    v_perm_b32 v15, v140, v136, s45
    v_mfma_f32_16x16x32_bf16 a[0:3], v[8:11], a[96:99], a[0:3]
    v_and_b32 v3, 15, v0
    v_and_b32 v4, 4, v0
    v_mfma_f32_16x16x32_bf16 a[32:35], v[8:11], a[100:103], a[32:35]
    v_lshlrev_b32 v4, 1, v4
    v_xor_b32 v4, v4, v3
    v_lshrrev_b32 v5, 4, v0
    v_lshlrev_b32 v5, 2, v5
    v_xor_b32 v4, v4, v5
    v_lshlrev_b32 v4, 4, v4
    v_lshl_add_u32 v4, v3, 8, v4
    v_add_u32 v252, s4, v4
    v_mfma_f32_16x16x32_bf16 a[36:39], v[12:15], a[100:103], a[36:39]
    buffer_load_dwordx4 v[72:75], v1, s[20:23], s42 offen
    s_waitcnt vmcnt(15)
    ds_read_b128 a[104:107], v252 offset:0
    v_mfma_f32_16x16x32_bf16 a[4:7], v[12:15], a[96:99], a[4:7]
    ds_read_b128 a[120:123], v252 offset:4096
    ds_read_b128 a[136:139], v252 offset:8192
    v_mfma_f32_16x16x32_bf16 v[212:215], v[12:15], a[92:95], v[212:215]
    v_perm_b32 v8, v117, v113, s44
    v_perm_b32 v9, v125, v121, s44
    v_mfma_f32_16x16x32_bf16 v[180:183], v[12:15], a[88:91], v[180:183]
    v_perm_b32 v10, v133, v129, s44
    v_perm_b32 v11, v141, v137, s44
    v_mfma_f32_16x16x32_bf16 v[148:151], v[12:15], a[84:87], v[148:151]
    s_nop 0
    v_mfma_f32_16x16x32_bf16 v[152:155], v[8:11], a[84:87], v[152:155]
    s_barrier
    buffer_load_dwordx4 v[76:79], v1, s[20:23], s43 offen
    v_mfma_f32_16x16x32_bf16 v[184:187], v[8:11], a[88:91], v[184:187]
    v_perm_b32 v12, v117, v113, s45
    v_perm_b32 v13, v125, v121, s45
    v_mfma_f32_16x16x32_bf16 v[216:219], v[8:11], a[92:95], v[216:219]
    v_perm_b32 v14, v133, v129, s45
    v_perm_b32 v15, v141, v137, s45
    v_mfma_f32_16x16x32_bf16 a[8:11], v[8:11], a[96:99], a[8:11]
    v_xor_b32 v2, 192, v2
    v_add_u32 v1, 0x40000, v1
    v_mfma_f32_16x16x32_bf16 a[40:43], v[8:11], a[100:103], a[40:43]
    ds_read_b128 a[64:67], v2 offset:20480
    ds_read_b128 a[152:155], v252 offset:12288
    v_and_b32 v1, 0x3fffff, v1
    buffer_load_dwordx4 v[80:83], v1, s[20:23], 0 offen
    ds_read_b128 a[168:171], v252 offset:16384
    v_xor_b32 v252, 16, v252
    ds_read_b128 a[108:111], v252 offset:0
    v_mfma_f32_16x16x32_bf16 a[44:47], v[12:15], a[100:103], a[44:47]
    ds_read_b128 a[68:71], v2 offset:24576
    buffer_load_dwordx4 v[84:87], v1, s[20:23], s37 offen
    v_mfma_f32_16x16x32_bf16 a[12:15], v[12:15], a[96:99], a[12:15]
    ds_read_b128 a[124:127], v252 offset:4096
    ds_read_b128 a[140:143], v252 offset:8192
    v_mfma_f32_16x16x32_bf16 v[220:223], v[12:15], a[92:95], v[220:223]
    ds_read_b128 a[156:159], v252 offset:12288
    v_perm_b32 v8, v118, v114, s44
    v_mfma_f32_16x16x32_bf16 v[188:191], v[12:15], a[88:91], v[188:191]
    v_perm_b32 v9, v126, v122, s44
    v_perm_b32 v10, v134, v130, s44
    v_mfma_f32_16x16x32_bf16 v[156:159], v[12:15], a[84:87], v[156:159]
    v_perm_b32 v11, v142, v138, s44
    s_nop 1
    v_mfma_f32_16x16x32_bf16 v[160:163], v[8:11], a[84:87], v[160:163]
    ds_read_b128 a[72:75], v2 offset:28672
    buffer_load_dwordx4 v[88:91], v1, s[20:23], s38 offen
    v_mfma_f32_16x16x32_bf16 v[192:195], v[8:11], a[88:91], v[192:195]
    buffer_load_dwordx4 v[92:95], v1, s[20:23], s39 offen
    ds_read_b128 a[172:175], v252 offset:16384
    v_mfma_f32_16x16x32_bf16 v[224:227], v[8:11], a[92:95], v[224:227]
    v_perm_b32 v12, v118, v114, s45
    v_perm_b32 v13, v126, v122, s45
    v_mfma_f32_16x16x32_bf16 a[16:19], v[8:11], a[96:99], a[16:19]
    v_perm_b32 v14, v134, v130, s45
    v_perm_b32 v15, v142, v138, s45
    v_mfma_f32_16x16x32_bf16 a[48:51], v[8:11], a[100:103], a[48:51]
    v_xor_b32 v252, 48, v252
    ds_read_b128 a[112:115], v252 offset:0
    ds_read_b128 a[128:131], v252 offset:4096
    v_mfma_f32_16x16x32_bf16 a[52:55], v[12:15], a[100:103], a[52:55]
    ds_read_b128 a[76:79], v2 offset:32768
    buffer_load_dwordx4 v[96:99], v1, s[20:23], s40 offen
    v_mfma_f32_16x16x32_bf16 a[20:23], v[12:15], a[96:99], a[20:23]
    ds_read_b128 a[144:147], v252 offset:8192
    ds_read_b128 a[160:163], v252 offset:12288
    v_mfma_f32_16x16x32_bf16 v[228:231], v[12:15], a[92:95], v[228:231]
    ds_read_b128 a[176:179], v252 offset:16384
    v_perm_b32 v8, v119, v115, s44
    v_mfma_f32_16x16x32_bf16 v[196:199], v[12:15], a[88:91], v[196:199]
    v_perm_b32 v9, v127, v123, s44
    v_perm_b32 v10, v135, v131, s44
    v_mfma_f32_16x16x32_bf16 v[164:167], v[12:15], a[84:87], v[164:167]
    v_perm_b32 v11, v143, v139, s44
    s_nop 1
    v_mfma_f32_16x16x32_bf16 v[168:171], v[8:11], a[84:87], v[168:171]
    ds_read_b128 a[80:83], v2 offset:36864
    buffer_load_dwordx4 v[100:103], v1, s[20:23], s41 offen
    v_mfma_f32_16x16x32_bf16 v[200:203], v[8:11], a[88:91], v[200:203]
    buffer_load_dwordx4 v[104:107], v1, s[20:23], s42 offen
    v_perm_b32 v12, v119, v115, s45
    v_mfma_f32_16x16x32_bf16 v[232:235], v[8:11], a[92:95], v[232:235]
    v_perm_b32 v13, v127, v123, s45
    v_perm_b32 v14, v135, v131, s45
    v_mfma_f32_16x16x32_bf16 a[24:27], v[8:11], a[96:99], a[24:27]
    v_perm_b32 v15, v143, v139, s45
    v_xor_b32 v252, 16, v252
    v_mfma_f32_16x16x32_bf16 a[56:59], v[8:11], a[100:103], a[56:59]
    ds_read_b128 a[116:119], v252 offset:0
    ds_read_b128 a[132:135], v252 offset:4096
    ds_read_b128 a[148:151], v252 offset:8192
    v_mfma_f32_16x16x32_bf16 a[60:63], v[12:15], a[100:103], a[60:63]
    buffer_load_dwordx4 v[108:111], v1, s[20:23], s43 offen
    ds_read_b128 a[164:167], v252 offset:12288
    v_mfma_f32_16x16x32_bf16 a[28:31], v[12:15], a[96:99], a[28:31]
    ds_read_b128 a[180:183], v252 offset:16384
    s_waitcnt vmcnt(16)
    v_perm_b32 v8, v20, v16, s44
    v_mfma_f32_16x16x32_bf16 v[236:239], v[12:15], a[92:95], v[236:239]
    v_perm_b32 v9, v28, v24, s44
    v_perm_b32 v10, v36, v32, s44
    v_mfma_f32_16x16x32_bf16 v[204:207], v[12:15], a[88:91], v[204:207]
    v_perm_b32 v11, v44, v40, s44
    v_add_u32 v1, 0x40000, v1
    v_mfma_f32_16x16x32_bf16 v[172:175], v[12:15], a[84:87], v[172:175]
    v_and_b32 v1, 0x3fffff, v1
    v_xor_b32 v242, 192, v2
    s_waitcnt lgkmcnt(2)
    v_mfma_f32_16x16x32_bf16 v[144:147], v[8:11], a[64:67], v[144:147]
    ds_read_b128 a[224:227], v242 offset:20480
    buffer_load_dwordx4 v[112:115], v1, s[20:23], 0 offen
    v_mfma_f32_16x16x32_bf16 v[176:179], v[8:11], a[68:71], v[176:179]
    v_perm_b32 v12, v20, v16, s45
    v_perm_b32 v13, v28, v24, s45
    v_mfma_f32_16x16x32_bf16 v[208:211], v[8:11], a[72:75], v[208:211]
    v_perm_b32 v14, v36, v32, s45
    v_perm_b32 v15, v44, v40, s45
    v_mfma_f32_16x16x32_bf16 a[0:3], v[8:11], a[76:79], a[0:3]
    v_bfe_u32 v3, v0, 3, 2
    v_lshlrev_b32 v3, 5, v3
    v_mfma_f32_16x16x32_bf16 a[32:35], v[8:11], a[80:83], a[32:35]
    v_and_b32 v5, 3, v0
    v_lshl_add_u32 v3, v5, 3, v3
    v_mfma_f32_16x16x32_bf16 a[36:39], v[12:15], a[80:83], a[36:39]
    ds_read_b128 a[228:231], v242 offset:24576
    buffer_load_dwordx4 v[116:119], v1, s[20:23], s37 offen
    v_mfma_f32_16x16x32_bf16 a[4:7], v[12:15], a[76:79], a[4:7]
    v_perm_b32 v8, v21, v17, s44
    v_perm_b32 v9, v29, v25, s44
    v_mfma_f32_16x16x32_bf16 v[212:215], v[12:15], a[72:75], v[212:215]
    v_perm_b32 v10, v37, v33, s44
    v_perm_b32 v11, v45, v41, s44
    v_mfma_f32_16x16x32_bf16 v[180:183], v[12:15], a[68:71], v[180:183]
    v_lshrrev_b32 v5, 2, v0
    v_lshl_add_u32 v3, v5, 7, v3
    v_mfma_f32_16x16x32_bf16 v[148:151], v[12:15], a[64:67], v[148:151]
    v_mfma_f32_16x16x32_bf16 v[152:155], v[8:11], a[64:67], v[152:155]
    ds_read_b128 a[232:235], v242 offset:28672
    buffer_load_dwordx4 v[120:123], v1, s[20:23], s38 offen
    v_mfma_f32_16x16x32_bf16 v[184:187], v[8:11], a[68:71], v[184:187]
    v_perm_b32 v12, v21, v17, s45
    v_perm_b32 v13, v29, v25, s45
    v_mfma_f32_16x16x32_bf16 v[216:219], v[8:11], a[72:75], v[216:219]
    v_perm_b32 v14, v37, v33, s45
    v_perm_b32 v15, v45, v41, s45
    v_mfma_f32_16x16x32_bf16 a[8:11], v[8:11], a[76:79], a[8:11]
    v_xor_b32 v2, 64, v2
    v_add_u32 v252, s4, v3
    v_mfma_f32_16x16x32_bf16 a[40:43], v[8:11], a[80:83], a[40:43]
    ds_read_b128 a[84:87], v2 offset:20480
    v_xor_b32 v253, 32, v252
    v_mfma_f32_16x16x32_bf16 a[44:47], v[12:15], a[80:83], a[44:47]
    ds_read_b128 a[236:239], v242 offset:32768
    ds_read_b128 a[88:91], v2 offset:24576
    v_mfma_f32_16x16x32_bf16 a[12:15], v[12:15], a[76:79], a[12:15]
    buffer_load_dwordx4 v[124:127], v1, s[20:23], s39 offen
    v_perm_b32 v8, v22, v18, s44
    v_mfma_f32_16x16x32_bf16 v[220:223], v[12:15], a[72:75], v[220:223]
    v_perm_b32 v9, v30, v26, s44
    v_perm_b32 v10, v38, v34, s44
    v_mfma_f32_16x16x32_bf16 v[188:191], v[12:15], a[68:71], v[188:191]
    v_perm_b32 v11, v46, v42, s44
    v_xor_b32 v254, 64, v252
    v_mfma_f32_16x16x32_bf16 v[156:159], v[12:15], a[64:67], v[156:159]
    v_xor_b32 v255, 96, v252
    v_mfma_f32_16x16x32_bf16 v[160:163], v[8:11], a[64:67], v[160:163]
    ds_read_b128 a[240:243], v242 offset:36864
    ds_read_b128 a[92:95], v2 offset:28672
    v_mfma_f32_16x16x32_bf16 v[192:195], v[8:11], a[68:71], v[192:195]
    buffer_load_dwordx4 v[128:131], v1, s[20:23], s40 offen
    v_perm_b32 v12, v22, v18, s45
    v_mfma_f32_16x16x32_bf16 v[224:227], v[8:11], a[72:75], v[224:227]
    v_perm_b32 v13, v30, v26, s45
    v_perm_b32 v14, v38, v34, s45
    v_mfma_f32_16x16x32_bf16 a[16:19], v[8:11], a[76:79], a[16:19]
    v_perm_b32 v15, v46, v42, s45
    v_lshrrev_b32 v4, 2, v0
    v_mfma_f32_16x16x32_bf16 a[48:51], v[8:11], a[80:83], a[48:51]
    v_and_b32 v5, 7, v4
    v_lshlrev_b32 v5, 5, v5
    v_and_b32 v3, 3, v0
    v_mfma_f32_16x16x32_bf16 a[52:55], v[12:15], a[80:83], a[52:55]
    ds_read_b128 a[96:99], v2 offset:32768
    buffer_load_dwordx4 v[132:135], v1, s[20:23], s41 offen
    v_mfma_f32_16x16x32_bf16 a[20:23], v[12:15], a[76:79], a[20:23]
    v_perm_b32 v8, v23, v19, s44
    v_perm_b32 v9, v31, v27, s44
    v_mfma_f32_16x16x32_bf16 v[228:231], v[12:15], a[72:75], v[228:231]
    v_perm_b32 v10, v39, v35, s44
    v_perm_b32 v11, v47, v43, s44
    v_mfma_f32_16x16x32_bf16 v[196:199], v[12:15], a[68:71], v[196:199]
    v_lshl_add_u32 v5, v3, 3, v5
    v_lshl_add_u32 v4, v4, 8, v5
    v_mfma_f32_16x16x32_bf16 v[164:167], v[12:15], a[64:67], v[164:167]
    v_mfma_f32_16x16x32_bf16 v[168:171], v[8:11], a[64:67], v[168:171]
    ds_read_b128 a[100:103], v2 offset:36864
    buffer_load_dwordx4 v[136:139], v1, s[20:23], s42 offen
    v_mfma_f32_16x16x32_bf16 v[200:203], v[8:11], a[68:71], v[200:203]
    s_lshl_b32 s3, s47, 12
    v_perm_b32 v12, v23, v19, s45
    v_mfma_f32_16x16x32_bf16 v[232:235], v[8:11], a[72:75], v[232:235]
    v_perm_b32 v13, v31, v27, s45
    v_perm_b32 v14, v39, v35, s45
    v_mfma_f32_16x16x32_bf16 a[24:27], v[8:11], a[76:79], a[24:27]
    v_perm_b32 v15, v47, v43, s45
    v_add_u32 v5, s4, v4
    v_mfma_f32_16x16x32_bf16 a[56:59], v[8:11], a[80:83], a[56:59]
    v_mfma_f32_16x16x32_bf16 a[60:63], v[12:15], a[80:83], a[60:63]
    buffer_load_dwordx4 v[140:143], v1, s[20:23], s43 offen
    s_lshl_b32 s59, s47, 12
    v_mfma_f32_16x16x32_bf16 a[28:31], v[12:15], a[76:79], a[28:31]
    s_add_u32 m0, s59, 0
    s_mov_b32 s7, 0
    v_mfma_f32_16x16x32_bf16 v[236:239], v[12:15], a[72:75], v[236:239]
    v_add_u32 v1, 0x40000, v1
    v_and_b32 v1, 0x3fffff, v1
    v_mfma_f32_16x16x32_bf16 v[204:207], v[12:15], a[68:71], v[204:207]
    v_add_u32 v4, s3, v4
    v_and_b32 v3, 15, v0
    v_mfma_f32_16x16x32_bf16 v[172:175], v[12:15], a[64:67], v[172:175]
    v_lshrrev_b32 v250, 4, v0
    v_lshlrev_b32 v251, 1, v250
    v_xor_b32 v3, v3, v251
    v_lshlrev_b32 v3, 4, v3
    v_lshl_add_u32 v250, v250, 8, v3
    v_xor_b32 v251, 0x80, v250
    buffer_load_dwordx4 v250, s[16:19], s7 offen offset:0 nt lds
    buffer_load_dwordx4 v251, s[16:19], s7 offen offset:1024 nt lds
    buffer_load_dwordx4 v250, s[16:19], s7 offen offset:2048 nt lds
    buffer_load_dwordx4 v251, s[16:19], s7 offen offset:3072 nt lds
    s_mov_b32 s7, 4096
    v_xor_b32 v2, 192, v2
    s_waitcnt vmcnt(20)
    v_perm_b32 v16, v52, v48, s44
    v_perm_b32 v17, v60, v56, s44
    v_perm_b32 v18, v68, v64, s44
    v_perm_b32 v19, v76, v72, s44
    v_perm_b32 v20, v52, v48, s45
    v_perm_b32 v21, v60, v56, s45
    s_waitcnt lgkmcnt(0)
    v_mfma_f32_16x16x32_bf16 v[144:147], v[16:19], a[84:87], v[144:147]
    ds_read_b128 a[64:67], v2 offset:20480
    ds_read_b128 a[68:71], v2 offset:24576
    v_mfma_f32_16x16x32_bf16 v[176:179], v[16:19], a[88:91], v[176:179]
    ds_read_b128 a[72:75], v2 offset:28672
    ds_read_b128 a[76:79], v2 offset:32768
    v_mfma_f32_16x16x32_bf16 v[208:211], v[16:19], a[92:95], v[208:211]
    ds_read_b128 a[80:83], v2 offset:36864
    v_perm_b32 v22, v68, v64, s45
    v_mfma_f32_16x16x32_bf16 a[0:3], v[16:19], a[96:99], a[0:3]
    v_perm_b32 v23, v76, v72, s45
    v_perm_b32 v24, v53, v49, s44
    v_mfma_f32_16x16x32_bf16 a[32:35], v[16:19], a[100:103], a[32:35]
    s_add_u32 m0, s59, 16384
    v_perm_b32 v25, v61, v57, s44
    v_mfma_f32_16x16x32_bf16 v[148:151], v[20:23], a[84:87], v[148:151]
    buffer_load_dwordx4 v250, s[16:19], s7 offen offset:0 nt lds
    s_add_u32 m0, s59, 16384
    v_mfma_f32_16x16x32_bf16 v[180:183], v[20:23], a[88:91], v[180:183]
    s_mov_b32 s7, 4096
    buffer_load_dwordx4 v251, s[16:19], s7 offen offset:1024 nt lds
    v_mfma_f32_16x16x32_bf16 v[212:215], v[20:23], a[92:95], v[212:215]
    s_add_u32 m0, s59, 16384
    s_mov_b32 s7, 4096
    v_mfma_f32_16x16x32_bf16 a[4:7], v[20:23], a[96:99], a[4:7]
    buffer_load_dwordx4 v250, s[16:19], s7 offen offset:2048 nt lds
    s_add_u32 m0, s59, 16384
    v_mfma_f32_16x16x32_bf16 a[36:39], v[20:23], a[100:103], a[36:39]
    s_mov_b32 s7, 4096
    buffer_load_dwordx4 v251, s[16:19], s7 offen offset:3072 nt lds
    s_mov_b32 s7, 8192
    v_perm_b32 v26, v69, v65, s44
    v_perm_b32 v27, v77, v73, s44
    v_perm_b32 v28, v53, v49, s45
    v_perm_b32 v29, v61, v57, s45
    v_mfma_f32_16x16x32_bf16 v[152:155], v[24:27], a[84:87], v[152:155]
    v_perm_b32 v30, v69, v65, s45
    v_perm_b32 v31, v77, v73, s45
    v_mfma_f32_16x16x32_bf16 v[184:187], v[24:27], a[88:91], v[184:187]
    v_perm_b32 v32, v54, v50, s44
    v_perm_b32 v33, v62, v58, s44
    v_mfma_f32_16x16x32_bf16 v[156:159], v[28:31], a[84:87], v[156:159]
    v_perm_b32 v34, v70, v66, s44
    v_perm_b32 v35, v78, v74, s44
    v_mfma_f32_16x16x32_bf16 v[188:191], v[28:31], a[88:91], v[188:191]
    v_perm_b32 v36, v54, v50, s45
    v_perm_b32 v37, v62, v58, s45
    v_mfma_f32_16x16x32_bf16 v[160:163], v[32:35], a[84:87], v[160:163]
    v_perm_b32 v38, v70, v66, s45
    v_perm_b32 v39, v78, v74, s45
    v_mfma_f32_16x16x32_bf16 v[192:195], v[32:35], a[88:91], v[192:195]
    v_perm_b32 v40, v55, v51, s44
    v_perm_b32 v41, v63, v59, s44
    v_mfma_f32_16x16x32_bf16 v[164:167], v[36:39], a[84:87], v[164:167]
    v_perm_b32 v42, v71, v67, s44
    v_perm_b32 v43, v79, v75, s44
    v_mfma_f32_16x16x32_bf16 v[196:199], v[36:39], a[88:91], v[196:199]
    v_perm_b32 v44, v55, v51, s45
    v_perm_b32 v45, v63, v59, s45
    v_mfma_f32_16x16x32_bf16 v[168:171], v[40:43], a[84:87], v[168:171]
    v_perm_b32 v46, v71, v67, s45
    v_perm_b32 v47, v79, v75, s45
    v_mfma_f32_16x16x32_bf16 v[200:203], v[40:43], a[88:91], v[200:203]
    s_waitcnt vmcnt(16)
    v_perm_b32 v48, v84, v80, s44
    v_perm_b32 v49, v92, v88, s44
    v_mfma_f32_16x16x32_bf16 v[172:175], v[44:47], a[84:87], v[172:175]
    v_perm_b32 v50, v100, v96, s44
    v_perm_b32 v51, v108, v104, s44
    v_mfma_f32_16x16x32_bf16 v[204:207], v[44:47], a[88:91], v[204:207]
    v_perm_b32 v52, v84, v80, s45
    v_perm_b32 v53, v92, v88, s45
    s_waitcnt lgkmcnt(0)
    v_mfma_f32_16x16x32_bf16 v[144:147], v[48:51], a[64:67], v[144:147]
    v_perm_b32 v54, v100, v96, s45
    v_perm_b32 v55, v108, v104, s45
    v_mfma_f32_16x16x32_bf16 v[176:179], v[48:51], a[68:71], v[176:179]
    v_perm_b32 v56, v85, v81, s44
    v_perm_b32 v57, v93, v89, s44
    v_mfma_f32_16x16x32_bf16 v[148:151], v[52:55], a[64:67], v[148:151]
    v_perm_b32 v58, v101, v97, s44
    v_perm_b32 v59, v109, v105, s44
    v_mfma_f32_16x16x32_bf16 v[180:183], v[52:55], a[68:71], v[180:183]
    v_perm_b32 v60, v85, v81, s45
    v_perm_b32 v61, v93, v89, s45
    v_mfma_f32_16x16x32_bf16 v[152:155], v[56:59], a[64:67], v[152:155]
    v_perm_b32 v62, v101, v97, s45
    v_perm_b32 v63, v109, v105, s45
    v_mfma_f32_16x16x32_bf16 v[184:187], v[56:59], a[68:71], v[184:187]
    v_perm_b32 v64, v86, v82, s44
    v_perm_b32 v65, v94, v90, s44
    v_mfma_f32_16x16x32_bf16 v[156:159], v[60:63], a[64:67], v[156:159]
    s_add_u32 m0, s59, 32768
    v_perm_b32 v66, v102, v98, s44
    v_mfma_f32_16x16x32_bf16 v[188:191], v[60:63], a[68:71], v[188:191]
    buffer_load_dwordx4 v250, s[16:19], s7 offen offset:0 nt lds
    s_mov_b32 s7, 8192
    v_mfma_f32_16x16x32_bf16 v[216:219], v[24:27], a[92:95], v[216:219]
    v_perm_b32 v67, v110, v106, s44
    v_perm_b32 v68, v86, v82, s45
    v_mfma_f32_16x16x32_bf16 v[220:223], v[28:31], a[92:95], v[220:223]
    v_perm_b32 v69, v94, v90, s45
    v_perm_b32 v70, v102, v98, s45
    v_mfma_f32_16x16x32_bf16 v[160:163], v[64:67], a[64:67], v[160:163]
    v_perm_b32 v71, v110, v106, s45
    v_perm_b32 v72, v87, v83, s44
    v_mfma_f32_16x16x32_bf16 v[192:195], v[64:67], a[68:71], v[192:195]
    v_perm_b32 v73, v95, v91, s44
    v_perm_b32 v74, v103, v99, s44
    v_mfma_f32_16x16x32_bf16 v[164:167], v[68:71], a[64:67], v[164:167]
    v_perm_b32 v75, v111, v107, s44
    v_perm_b32 v76, v87, v83, s45
    v_mfma_f32_16x16x32_bf16 v[196:199], v[68:71], a[68:71], v[196:199]
    v_perm_b32 v77, v95, v91, s45
    v_perm_b32 v78, v103, v99, s45
    v_mfma_f32_16x16x32_bf16 v[168:171], v[72:75], a[64:67], v[168:171]
    v_perm_b32 v79, v111, v107, s45
    s_waitcnt vmcnt(9)
    v_perm_b32 v80, v116, v112, s44
    v_mfma_f32_16x16x32_bf16 v[200:203], v[72:75], a[68:71], v[200:203]
    v_perm_b32 v81, v124, v120, s44
    v_perm_b32 v82, v132, v128, s44
    v_mfma_f32_16x16x32_bf16 v[172:175], v[76:79], a[64:67], v[172:175]
    v_perm_b32 v83, v140, v136, s44
    v_perm_b32 v84, v116, v112, s45
    v_mfma_f32_16x16x32_bf16 v[204:207], v[76:79], a[68:71], v[204:207]
    v_perm_b32 v85, v124, v120, s45
    v_perm_b32 v86, v132, v128, s45
    v_mfma_f32_16x16x32_bf16 v[144:147], v[80:83], a[224:227], v[144:147]
    v_perm_b32 v87, v140, v136, s45
    v_perm_b32 v88, v117, v113, s44
    v_mfma_f32_16x16x32_bf16 v[176:179], v[80:83], a[228:231], v[176:179]
    v_perm_b32 v89, v125, v121, s44
    v_perm_b32 v90, v133, v129, s44
    v_mfma_f32_16x16x32_bf16 v[148:151], v[84:87], a[224:227], v[148:151]
    v_perm_b32 v91, v141, v137, s44
    v_perm_b32 v92, v117, v113, s45
    v_mfma_f32_16x16x32_bf16 v[180:183], v[84:87], a[228:231], v[180:183]
    v_perm_b32 v93, v125, v121, s45
    v_perm_b32 v94, v133, v129, s45
    v_mfma_f32_16x16x32_bf16 v[152:155], v[88:91], a[224:227], v[152:155]
    s_add_u32 m0, s59, 32768
    v_perm_b32 v95, v141, v137, s45
    v_mfma_f32_16x16x32_bf16 v[184:187], v[88:91], a[228:231], v[184:187]
    buffer_load_dwordx4 v251, s[16:19], s7 offen offset:1024 nt lds
    s_mov_b32 s7, 8192
    v_mfma_f32_16x16x32_bf16 v[156:159], v[92:95], a[224:227], v[156:159]
    v_perm_b32 v96, v118, v114, s44
    v_perm_b32 v97, v126, v122, s44
    v_mfma_f32_16x16x32_bf16 v[188:191], v[92:95], a[228:231], v[188:191]
    v_perm_b32 v98, v134, v130, s44
    v_perm_b32 v99, v142, v138, s44
    v_mfma_f32_16x16x32_bf16 v[224:227], v[32:35], a[92:95], v[224:227]
    v_perm_b32 v100, v118, v114, s45
    v_perm_b32 v101, v126, v122, s45
    v_mfma_f32_16x16x32_bf16 v[160:163], v[96:99], a[224:227], v[160:163]
    v_perm_b32 v102, v134, v130, s45
    v_perm_b32 v103, v142, v138, s45
    v_mfma_f32_16x16x32_bf16 v[192:195], v[96:99], a[228:231], v[192:195]
    v_perm_b32 v104, v119, v115, s44
    v_perm_b32 v105, v127, v123, s44
    v_mfma_f32_16x16x32_bf16 v[164:167], v[100:103], a[224:227], v[164:167]
    v_perm_b32 v106, v135, v131, s44
    v_perm_b32 v107, v143, v139, s44
    v_mfma_f32_16x16x32_bf16 v[196:199], v[100:103], a[228:231], v[196:199]
    v_perm_b32 v108, v119, v115, s45
    v_perm_b32 v109, v127, v123, s45
    v_mfma_f32_16x16x32_bf16 v[168:171], v[104:107], a[224:227], v[168:171]
    v_perm_b32 v110, v135, v131, s45
    v_perm_b32 v111, v143, v139, s45
    v_mfma_f32_16x16x32_bf16 v[200:203], v[104:107], a[228:231], v[200:203]
    v_cvt_pk_bf16_f32 v112, v144, v148
    v_cvt_pk_bf16_f32 v113, v152, v156
    v_mfma_f32_16x16x32_bf16 v[172:175], v[108:111], a[224:227], v[172:175]
    v_cvt_pk_bf16_f32 v114, v160, v164
    v_cvt_pk_bf16_f32 v116, v145, v149
    v_mfma_f32_16x16x32_bf16 v[204:207], v[108:111], a[228:231], v[204:207]
    v_cvt_pk_bf16_f32 v120, v146, v150
    v_cvt_pk_bf16_f32 v124, v147, v151
    v_mfma_f32_16x16x32_bf16 v[228:231], v[36:39], a[92:95], v[228:231]
    v_cvt_pk_bf16_f32 v117, v153, v157
    v_cvt_pk_bf16_f32 v121, v154, v158
    v_mfma_f32_16x16x32_bf16 v[232:235], v[40:43], a[92:95], v[232:235]
    v_cvt_pk_bf16_f32 v115, v168, v172
    v_cvt_pk_bf16_f32 v125, v155, v159
    v_mfma_f32_16x16x32_bf16 v[236:239], v[44:47], a[92:95], v[236:239]
    v_cvt_pk_bf16_f32 v118, v161, v165
    v_cvt_pk_bf16_f32 v119, v169, v173
    v_mfma_f32_16x16x32_bf16 v[144:147], a[104:107], v[112:115], 0
    s_add_u32 m0, s59, 32768
    v_cvt_pk_bf16_f32 v122, v162, v166
    v_mfma_f32_16x16x32_bf16 v[148:151], a[120:123], v[112:115], 0
    buffer_load_dwordx4 v250, s[16:19], s7 offen offset:2048 nt lds
    s_mov_b32 s7, 8192
    v_mfma_f32_16x16x32_bf16 v[152:155], a[136:139], v[112:115], 0
    v_cvt_pk_bf16_f32 v126, v163, v167
    v_cvt_pk_bf16_f32 v123, v170, v174
    v_mfma_f32_16x16x32_bf16 v[156:159], a[152:155], v[112:115], 0
    v_cvt_pk_bf16_f32 v127, v171, v175
    v_cvt_pk_bf16_f32 v128, v176, v180
    v_mfma_f32_16x16x32_bf16 v[160:163], a[168:171], v[112:115], 0
    v_cvt_pk_bf16_f32 v129, v184, v188
    v_cvt_pk_bf16_f32 v130, v192, v196
    v_mfma_f32_16x16x32_bf16 v[144:147], a[108:111], v[116:119], v[144:147]
    v_cvt_pk_bf16_f32 v131, v200, v204
    v_cvt_pk_bf16_f32 v132, v177, v181
    v_mfma_f32_16x16x32_bf16 v[148:151], a[124:127], v[116:119], v[148:151]
    v_cvt_pk_bf16_f32 v136, v178, v182
    v_cvt_pk_bf16_f32 v140, v179, v183
    v_mfma_f32_16x16x32_bf16 v[152:155], a[140:143], v[116:119], v[152:155]
    v_cvt_pk_bf16_f32 v133, v185, v189
    v_cvt_pk_bf16_f32 v137, v186, v190
    v_mfma_f32_16x16x32_bf16 v[156:159], a[156:159], v[116:119], v[156:159]
    v_cvt_pk_bf16_f32 v141, v187, v191
    v_cvt_pk_bf16_f32 v134, v193, v197
    v_mfma_f32_16x16x32_bf16 v[160:163], a[172:175], v[116:119], v[160:163]
    v_cvt_pk_bf16_f32 v135, v201, v205
    v_cvt_pk_bf16_f32 v138, v194, v198
    v_mfma_f32_16x16x32_bf16 v[144:147], a[112:115], v[120:123], v[144:147]
    v_cvt_pk_bf16_f32 v142, v195, v199
    v_cvt_pk_bf16_f32 v139, v202, v206
    v_mfma_f32_16x16x32_bf16 v[148:151], a[128:131], v[120:123], v[148:151]
    v_cvt_pk_bf16_f32 v143, v203, v207
    v_lshl_add_u32 v1, v0, 4, s99
    v_mfma_f32_16x16x32_bf16 v[152:155], a[144:147], v[120:123], v[152:155]
    v_lshlrev_b32 v2, 4, v0
    v_mfma_f32_16x16x32_bf16 v[156:159], a[160:163], v[120:123], v[156:159]
    v_mfma_f32_16x16x32_bf16 v[160:163], a[176:179], v[120:123], v[160:163]
    v_mfma_f32_16x16x32_bf16 v[144:147], a[116:119], v[124:127], v[144:147]
    v_mfma_f32_16x16x32_bf16 v[148:151], a[132:135], v[124:127], v[148:151]
    s_add_u32 m0, s59, 32768
    v_mfma_f32_16x16x32_bf16 v[152:155], a[148:151], v[124:127], v[152:155]
    buffer_load_dwordx4 v251, s[16:19], s7 offen offset:3072 nt lds
    s_mov_b32 s7, 12288
    v_mfma_f32_16x16x32_bf16 v[156:159], a[164:167], v[124:127], v[156:159]
    v_mfma_f32_16x16x32_bf16 v[160:163], a[180:183], v[124:127], v[160:163]
    s_nop 0
    v_max3_f32 v240, v144, v145, v146
    v_mfma_f32_16x16x32_bf16 v[208:211], v[48:51], a[72:75], v[208:211]
    v_max3_f32 v241, v147, v148, v149
    v_max3_f32 v240, v240, v150, v151
    v_mfma_f32_16x16x32_bf16 v[212:215], v[52:55], a[72:75], v[212:215]
    v_max3_f32 v241, v241, v152, v153
    v_max3_f32 v240, v240, v154, v155
    v_mfma_f32_16x16x32_bf16 v[216:219], v[56:59], a[72:75], v[216:219]
    v_max3_f32 v241, v241, v156, v157
    v_max3_f32 v240, v240, v158, v159
    v_mfma_f32_16x16x32_bf16 v[220:223], v[60:63], a[72:75], v[220:223]
    v_max3_f32 v241, v241, v160, v161
    v_max3_f32 v240, v240, v162, v163
    v_mfma_f32_16x16x32_bf16 v[224:227], v[64:67], a[72:75], v[224:227]
    v_max_f32 v240, v240, v241
    v_mov_b32 v242, v240
    v_mfma_f32_16x16x32_bf16 v[228:231], v[68:71], a[72:75], v[228:231]
    s_nop 0
    v_permlane32_swap_b32 v240, v242
    v_mfma_f32_16x16x32_bf16 v[232:235], v[72:75], a[72:75], v[232:235]
    v_max_f32 v240, v240, v242
    v_mov_b32 v242, v240
    v_mfma_f32_16x16x32_bf16 v[236:239], v[76:79], a[72:75], v[236:239]
    s_nop 0
    v_permlane16_swap_b32 v240, v242
    v_mfma_f32_16x16x32_bf16 v[176:179], a[104:107], v[128:131], 0
    v_max_f32 v240, v240, v242
    v_mul_f32 v240, s46, v240
    v_mfma_f32_16x16x32_bf16 v[180:183], a[120:123], v[128:131], 0
    v_fma_f32 v144, v144, s46, -v240
    v_fma_f32 v145, v145, s46, -v240
    v_mfma_f32_16x16x32_bf16 v[208:211], v[80:83], a[232:235], v[208:211]
    v_fma_f32 v146, v146, s46, -v240
    v_fma_f32 v147, v147, s46, -v240
    v_mfma_f32_16x16x32_bf16 v[212:215], v[84:87], a[232:235], v[212:215]
    v_fma_f32 v148, v148, s46, -v240
    v_fma_f32 v149, v149, s46, -v240
    v_mfma_f32_16x16x32_bf16 v[216:219], v[88:91], a[232:235], v[216:219]
    s_add_u32 m0, s4, 0
    v_exp_f32 v144, v144
    v_mfma_f32_16x16x32_bf16 v[220:223], v[92:95], a[232:235], v[220:223]
    buffer_load_dwordx4 v250, s[16:19], s7 offen offset:0 nt lds
    s_mov_b32 s7, 12288
    v_mfma_f32_16x16x32_bf16 v[224:227], v[96:99], a[232:235], v[224:227]
    v_exp_f32 v145, v145
    v_mfma_f32_16x16x32_bf16 v[228:231], v[100:103], a[232:235], v[228:231]
    v_exp_f32 v146, v146
    v_mfma_f32_16x16x32_bf16 v[232:235], v[104:107], a[232:235], v[232:235]
    v_exp_f32 v147, v147
    v_mfma_f32_16x16x32_bf16 v[236:239], v[108:111], a[232:235], v[236:239]
    v_fma_f32 v150, v150, s46, -v240
    v_fma_f32 v151, v151, s46, -v240
    v_mfma_f32_16x16x32_bf16 v[184:187], a[136:139], v[128:131], 0
    v_exp_f32 v148, v148
    v_mfma_f32_16x16x32_bf16 v[188:191], a[152:155], v[128:131], 0
    v_exp_f32 v149, v149
    v_mfma_f32_16x16x32_bf16 v[192:195], a[168:171], v[128:131], 0
    v_fma_f32 v152, v152, s46, -v240
    v_fma_f32 v153, v153, s46, -v240
    v_mfma_f32_16x16x32_bf16 v[176:179], a[108:111], v[132:135], v[176:179]
    v_exp_f32 v150, v150
    v_mfma_f32_16x16x32_bf16 v[180:183], a[124:127], v[132:135], v[180:183]
    v_exp_f32 v151, v151
    v_mfma_f32_16x16x32_bf16 v[184:187], a[140:143], v[132:135], v[184:187]
    v_add_f32 v242, v144, v146
    v_add_f32 v243, v145, v147
    v_mfma_f32_16x16x32_bf16 v[188:191], a[156:159], v[132:135], v[188:191]
    v_fma_f32 v154, v154, s46, -v240
    v_fma_f32 v155, v155, s46, -v240
    v_mfma_f32_16x16x32_bf16 v[192:195], a[172:175], v[132:135], v[192:195]
    v_exp_f32 v152, v152
    v_mfma_f32_16x16x32_bf16 v[176:179], a[112:115], v[136:139], v[176:179]
    v_exp_f32 v153, v153
    v_mfma_f32_16x16x32_bf16 v[180:183], a[128:131], v[136:139], v[180:183]
    v_add_f32 v242, v242, v148
    v_add_f32 v243, v243, v149
    v_mfma_f32_16x16x32_bf16 v[184:187], a[144:147], v[136:139], v[184:187]
    s_add_u32 m0, s4, 0
    v_fma_f32 v156, v156, s46, -v240
    v_mfma_f32_16x16x32_bf16 v[188:191], a[160:163], v[136:139], v[188:191]
    buffer_load_dwordx4 v251, s[16:19], s7 offen offset:1024 nt lds
    s_mov_b32 s7, 12288
    v_mfma_f32_16x16x32_bf16 v[192:195], a[176:179], v[136:139], v[192:195]
    v_fma_f32 v157, v157, s46, -v240
    v_exp_f32 v154, v154
    v_mfma_f32_16x16x32_bf16 v[176:179], a[116:119], v[140:143], v[176:179]
    v_exp_f32 v155, v155
    v_mfma_f32_16x16x32_bf16 v[180:183], a[132:135], v[140:143], v[180:183]
    v_add_f32 v242, v242, v150
    v_add_f32 v243, v243, v151
    v_mfma_f32_16x16x32_bf16 v[184:187], a[148:151], v[140:143], v[184:187]
    v_fma_f32 v158, v158, s46, -v240
    v_fma_f32 v159, v159, s46, -v240
    v_mfma_f32_16x16x32_bf16 v[188:191], a[164:167], v[140:143], v[188:191]
    v_exp_f32 v156, v156
    v_mfma_f32_16x16x32_bf16 v[192:195], a[180:183], v[140:143], v[192:195]
    v_exp_f32 v157, v157
    v_mfma_f32_16x16x32_bf16 a[8:11], v[24:27], a[96:99], a[8:11]
    v_add_f32 v242, v242, v152
    v_add_f32 v243, v243, v153
    v_mfma_f32_16x16x32_bf16 a[12:15], v[28:31], a[96:99], a[12:15]
    v_fma_f32 v160, v160, s46, -v240
    v_fma_f32 v161, v161, s46, -v240
    v_mfma_f32_16x16x32_bf16 a[16:19], v[32:35], a[96:99], a[16:19]
    v_exp_f32 v158, v158
    v_mfma_f32_16x16x32_bf16 a[20:23], v[36:39], a[96:99], a[20:23]
    v_exp_f32 v159, v159
    v_mfma_f32_16x16x32_bf16 a[24:27], v[40:43], a[96:99], a[24:27]
    v_add_f32 v242, v242, v154
    v_add_f32 v243, v243, v155
    v_mfma_f32_16x16x32_bf16 a[28:31], v[44:47], a[96:99], a[28:31]
    v_fma_f32 v162, v162, s46, -v240
    v_fma_f32 v163, v163, s46, -v240
    v_mfma_f32_16x16x32_bf16 a[40:43], v[24:27], a[100:103], a[40:43]
    v_exp_f32 v160, v160
    v_mfma_f32_16x16x32_bf16 a[44:47], v[28:31], a[100:103], a[44:47]
    v_exp_f32 v161, v161
    v_mfma_f32_16x16x32_bf16 a[48:51], v[32:35], a[100:103], a[48:51]
    s_add_u32 m0, s4, 0
    v_add_f32 v242, v242, v156
    v_mfma_f32_16x16x32_bf16 a[52:55], v[36:39], a[100:103], a[52:55]
    buffer_load_dwordx4 v250, s[16:19], s7 offen offset:2048 nt lds
    s_mov_b32 s7, 12288
    v_mfma_f32_16x16x32_bf16 a[56:59], v[40:43], a[100:103], a[56:59]
    v_add_f32 v243, v243, v157
    v_exp_f32 v162, v162
    v_mfma_f32_16x16x32_bf16 a[60:63], v[44:47], a[100:103], a[60:63]
    v_exp_f32 v163, v163
    v_mfma_f32_16x16x32_bf16 a[0:3], v[48:51], a[76:79], a[0:3]
    v_add_f32 v242, v242, v158
    v_add_f32 v243, v243, v159
    v_mfma_f32_16x16x32_bf16 a[4:7], v[52:55], a[76:79], a[4:7]
    v_add_f32 v242, v242, v160
    v_add_f32 v243, v243, v161
    v_mfma_f32_16x16x32_bf16 a[8:11], v[56:59], a[76:79], a[8:11]
    v_add_f32 v242, v242, v162
    v_add_f32 v243, v243, v163
    v_mfma_f32_16x16x32_bf16 a[12:15], v[60:63], a[76:79], a[12:15]
    v_add_f32 v242, v242, v243
    v_mov_b32 v241, v242
    v_mfma_f32_16x16x32_bf16 a[16:19], v[64:67], a[76:79], a[16:19]
    v_cvt_pk_bf16_f32 v112, v208, v212
    v_permlane32_swap_b32 v242, v241
    v_mfma_f32_16x16x32_bf16 a[20:23], v[68:71], a[76:79], a[20:23]
    v_add_f32 v242, v242, v241
    v_mov_b32 v241, v242
    v_mfma_f32_16x16x32_bf16 a[24:27], v[72:75], a[76:79], a[24:27]
    v_cvt_pk_bf16_f32 v113, v216, v220
    v_permlane16_swap_b32 v242, v241
    v_mfma_f32_16x16x32_bf16 a[28:31], v[76:79], a[76:79], a[28:31]
    v_add_f32 v242, v242, v241
    v_rcp_f32 v242, v242
    v_mfma_f32_16x16x32_bf16 a[32:35], v[48:51], a[80:83], a[32:35]
    v_mul_f32 v144, v144, v242
    v_mul_f32 v145, v145, v242
    v_mfma_f32_16x16x32_bf16 a[36:39], v[52:55], a[80:83], a[36:39]
    v_mul_f32 v146, v146, v242
    v_mul_f32 v147, v147, v242
    v_mfma_f32_16x16x32_bf16 a[40:43], v[56:59], a[80:83], a[40:43]
    v_cvt_pk_bf16_f32 v164, v144, v145
    v_cvt_pk_bf16_f32 v165, v146, v147
    v_mfma_f32_16x16x32_bf16 a[44:47], v[60:63], a[80:83], a[44:47]
    v_mul_f32 v148, v148, v242
    s_add_u32 m0, s4, 0
    v_mfma_f32_16x16x32_bf16 a[48:51], v[64:67], a[80:83], a[48:51]
    buffer_load_dwordx4 v251, s[16:19], s7 offen offset:3072 nt lds
    s_mov_b32 s7, 16384
    v_mfma_f32_16x16x32_bf16 a[52:55], v[68:71], a[80:83], a[52:55]
    v_mul_f32 v149, v149, v242
    v_mul_f32 v150, v150, v242
    v_mfma_f32_16x16x32_bf16 a[56:59], v[72:75], a[80:83], a[56:59]
    v_mul_f32 v151, v151, v242
    v_cvt_pk_bf16_f32 v114, v224, v228
    v_mfma_f32_16x16x32_bf16 a[60:63], v[76:79], a[80:83], a[60:63]
    v_cvt_pk_bf16_f32 v115, v232, v236
    v_cvt_pk_bf16_f32 v166, v148, v149
    v_mfma_f32_16x16x32_bf16 a[0:3], v[80:83], a[236:239], a[0:3]
    v_cvt_pk_bf16_f32 v167, v150, v151
    v_mul_f32 v152, v152, v242
    v_mfma_f32_16x16x32_bf16 v[144:147], a[104:107], v[112:115], 0
    v_mul_f32 v153, v153, v242
    v_mul_f32 v154, v154, v242
    v_mfma_f32_16x16x32_bf16 v[148:151], a[120:123], v[112:115], 0
    v_mul_f32 v155, v155, v242
    v_cvt_pk_bf16_f32 v168, v152, v153
    v_mfma_f32_16x16x32_bf16 a[4:7], v[84:87], a[236:239], a[4:7]
    v_cvt_pk_bf16_f32 v169, v154, v155
    v_mul_f32 v156, v156, v242
    v_mfma_f32_16x16x32_bf16 v[152:155], a[136:139], v[112:115], 0
    v_mul_f32 v157, v157, v242
    v_mul_f32 v158, v158, v242
    v_mfma_f32_16x16x32_bf16 a[8:11], v[88:91], a[236:239], a[8:11]
    v_mul_f32 v159, v159, v242
    v_cvt_pk_bf16_f32 v170, v156, v157
    v_mfma_f32_16x16x32_bf16 a[12:15], v[92:95], a[236:239], a[12:15]
    v_cvt_pk_bf16_f32 v171, v158, v159
    v_mul_f32 v160, v160, v242
    v_mfma_f32_16x16x32_bf16 v[156:159], a[152:155], v[112:115], 0
    v_mul_f32 v161, v161, v242
    v_mul_f32 v162, v162, v242
    v_mfma_f32_16x16x32_bf16 a[16:19], v[96:99], a[236:239], a[16:19]
    v_mul_f32 v163, v163, v242
    v_cvt_pk_bf16_f32 v172, v160, v161
    v_mfma_f32_16x16x32_bf16 a[20:23], v[100:103], a[236:239], a[20:23]
    v_cvt_pk_bf16_f32 v173, v162, v163
    v_cvt_pk_bf16_f32 v116, v209, v213
    v_mfma_f32_16x16x32_bf16 v[160:163], a[168:171], v[112:115], 0
    v_cvt_pk_bf16_f32 v117, v217, v221
    v_cvt_pk_bf16_f32 v118, v225, v229
    v_mfma_f32_16x16x32_bf16 a[24:27], v[104:107], a[236:239], a[24:27]
    v_cvt_pk_bf16_f32 v119, v233, v237
    v_cvt_pk_bf16_f32 v120, v210, v214
    v_mfma_f32_16x16x32_bf16 a[28:31], v[108:111], a[236:239], a[28:31]
    s_add_u32 m0, s4, 4096
    v_cvt_pk_bf16_f32 v121, v218, v222
    v_mfma_f32_16x16x32_bf16 v[144:147], a[108:111], v[116:119], v[144:147]
    buffer_load_dwordx4 v250, s[16:19], s7 offen offset:0 nt lds
    s_mov_b32 s7, 16384
    v_mfma_f32_16x16x32_bf16 v[148:151], a[124:127], v[116:119], v[148:151]
    v_cvt_pk_bf16_f32 v122, v226, v230
    v_cvt_pk_bf16_f32 v123, v234, v238
    v_mfma_f32_16x16x32_bf16 v[152:155], a[140:143], v[116:119], v[152:155]
    v_max3_f32 v244, v176, v177, v178
    v_max3_f32 v245, v179, v180, v181
    v_mfma_f32_16x16x32_bf16 v[156:159], a[156:159], v[116:119], v[156:159]
    v_max3_f32 v244, v244, v182, v183
    v_cvt_pk_bf16_f32 v124, v211, v215
    v_mfma_f32_16x16x32_bf16 v[160:163], a[172:175], v[116:119], v[160:163]
    v_cvt_pk_bf16_f32 v125, v219, v223
    v_cvt_pk_bf16_f32 v126, v227, v231
    v_mfma_f32_16x16x32_bf16 v[144:147], a[112:115], v[120:123], v[144:147]
    v_cvt_pk_bf16_f32 v127, v235, v239
    v_max3_f32 v245, v245, v184, v185
    v_mfma_f32_16x16x32_bf16 v[148:151], a[128:131], v[120:123], v[148:151]
    v_max3_f32 v244, v244, v186, v187
    v_max3_f32 v245, v245, v188, v189
    v_mfma_f32_16x16x32_bf16 v[152:155], a[144:147], v[120:123], v[152:155]
    v_max3_f32 v244, v244, v190, v191
    v_max3_f32 v245, v245, v192, v193
    v_mfma_f32_16x16x32_bf16 v[156:159], a[160:163], v[120:123], v[156:159]
    v_max3_f32 v244, v244, v194, v195
    v_max_f32 v244, v244, v245
    v_mfma_f32_16x16x32_bf16 v[160:163], a[176:179], v[120:123], v[160:163]
    v_mov_b32 v246, v244
    v_accvgpr_read_b32 v174, a0
    v_mfma_f32_16x16x32_bf16 v[144:147], a[116:119], v[124:127], v[144:147]
    v_permlane32_swap_b32 v244, v246
    v_mfma_f32_16x16x32_bf16 v[148:151], a[132:135], v[124:127], v[148:151]
    v_max_f32 v244, v244, v246
    v_mov_b32 v246, v244
    v_mfma_f32_16x16x32_bf16 v[152:155], a[148:151], v[124:127], v[152:155]
    v_accvgpr_read_b32 v175, a4
    v_permlane16_swap_b32 v244, v246
    v_mfma_f32_16x16x32_bf16 v[156:159], a[164:167], v[124:127], v[156:159]
    v_max_f32 v244, v244, v246
    v_mul_f32 v244, s46, v244
    v_mfma_f32_16x16x32_bf16 v[160:163], a[180:183], v[124:127], v[160:163]
    v_fma_f32 v176, v176, s46, -v244
    v_fma_f32 v177, v177, s46, -v244
    v_mfma_f32_16x16x32_bf16 a[32:35], v[80:83], a[240:243], a[32:35]
    s_add_u32 m0, s4, 4096
    v_fma_f32 v178, v178, s46, -v244
    v_mfma_f32_16x16x32_bf16 a[36:39], v[84:87], a[240:243], a[36:39]
    buffer_load_dwordx4 v251, s[16:19], s7 offen offset:1024 nt lds
    s_mov_b32 s7, 16384
    v_mfma_f32_16x16x32_bf16 a[40:43], v[88:91], a[240:243], a[40:43]
    v_fma_f32 v179, v179, s46, -v244
    v_fma_f32 v180, v180, s46, -v244
    v_mfma_f32_16x16x32_bf16 a[44:47], v[92:95], a[240:243], a[44:47]
    v_fma_f32 v181, v181, s46, -v244
    v_exp_f32 v176, v176
    v_mfma_f32_16x16x32_bf16 a[48:51], v[96:99], a[240:243], a[48:51]
    v_exp_f32 v177, v177
    v_mfma_f32_16x16x32_bf16 a[52:55], v[100:103], a[240:243], a[52:55]
    v_exp_f32 v178, v178
    v_mfma_f32_16x16x32_bf16 a[56:59], v[104:107], a[240:243], a[56:59]
    v_exp_f32 v179, v179
    v_mfma_f32_16x16x32_bf16 a[60:63], v[108:111], a[240:243], a[60:63]
    v_max3_f32 v240, v144, v145, v146
    v_fma_f32 v182, v182, s46, -v244
    v_fma_f32 v183, v183, s46, -v244
    v_exp_f32 v180, v180
    v_exp_f32 v181, v181
    v_max3_f32 v241, v147, v148, v149
    v_max3_f32 v240, v240, v150, v151
    v_pk_fma_f32 v[184:185], v[184:185], s[46:47], v[244:245] op_sel_hi:[1,0,0] neg_lo:[0,0,1] neg_hi:[0,0,1]
    v_exp_f32 v182, v182
    v_exp_f32 v183, v183
    v_pk_add_f32 v[246:247], v[176:177], v[178:179]
    v_max3_f32 v241, v241, v152, v153
    v_max3_f32 v240, v240, v154, v155
    v_pk_fma_f32 v[186:187], v[186:187], s[46:47], v[244:245] op_sel_hi:[1,0,0] neg_lo:[0,0,1] neg_hi:[0,0,1]
    v_exp_f32 v184, v184
    v_exp_f32 v185, v185
    v_pk_add_f32 v[246:247], v[246:247], v[180:181]
    v_max3_f32 v241, v241, v156, v157
    v_max3_f32 v240, v240, v158, v159
    v_pk_fma_f32 v[188:189], v[188:189], s[46:47], v[244:245] op_sel_hi:[1,0,0] neg_lo:[0,0,1] neg_hi:[0,0,1]
    v_exp_f32 v186, v186
    v_exp_f32 v187, v187
    v_pk_add_f32 v[246:247], v[246:247], v[182:183]
    v_max3_f32 v241, v241, v160, v161
    s_add_u32 m0, s4, 4096
    s_nop 0
    buffer_load_dwordx4 v250, s[16:19], s7 offen offset:2048 nt lds
    s_mov_b32 s7, 16384
    v_max3_f32 v240, v240, v162, v163
    v_pk_fma_f32 v[190:191], v[190:191], s[46:47], v[244:245] op_sel_hi:[1,0,0] neg_lo:[0,0,1] neg_hi:[0,0,1]
    v_exp_f32 v188, v188
    v_exp_f32 v189, v189
    v_pk_add_f32 v[246:247], v[246:247], v[184:185]
    v_max_f32 v240, v240, v241
    v_pk_fma_f32 v[192:193], v[192:193], s[46:47], v[244:245] op_sel_hi:[1,0,0] neg_lo:[0,0,1] neg_hi:[0,0,1]
    v_exp_f32 v190, v190
    v_exp_f32 v191, v191
    v_pk_add_f32 v[246:247], v[246:247], v[186:187]
    v_mov_b32 v242, v240
    v_pk_fma_f32 v[194:195], v[194:195], s[46:47], v[244:245] op_sel_hi:[1,0,0] neg_lo:[0,0,1] neg_hi:[0,0,1]
    v_exp_f32 v192, v192
    v_exp_f32 v193, v193
    v_pk_add_f32 v[246:247], v[246:247], v[188:189]
    v_permlane32_swap_b32 v240, v242
    v_exp_f32 v194, v194
    v_exp_f32 v195, v195
    v_pk_add_f32 v[246:247], v[246:247], v[190:191]
    v_pk_add_f32 v[246:247], v[246:247], v[192:193]
    v_max_f32 v240, v240, v242
    v_pk_add_f32 v[246:247], v[246:247], v[194:195]
    v_mov_b32 v242, v240
    v_add_f32 v246, v246, v247
    v_mov_b32 v245, v246
    v_permlane16_swap_b32 v240, v242
    v_max_f32 v240, v240, v242
    v_permlane32_swap_b32 v246, v245
    v_mul_f32 v240, s46, v240
    v_add_f32 v246, v246, v245
    v_pk_fma_f32 v[144:145], v[144:145], s[46:47], v[240:241] op_sel_hi:[1,0,0] neg_lo:[0,0,1] neg_hi:[0,0,1]
    v_pk_fma_f32 v[146:147], v[146:147], s[46:47], v[240:241] op_sel_hi:[1,0,0] neg_lo:[0,0,1] neg_hi:[0,0,1]
    v_mov_b32 v245, v246
    v_pk_fma_f32 v[148:149], v[148:149], s[46:47], v[240:241] op_sel_hi:[1,0,0] neg_lo:[0,0,1] neg_hi:[0,0,1]
    v_exp_f32 v144, v144
    v_exp_f32 v145, v145
    v_exp_f32 v146, v146
    v_exp_f32 v147, v147
    v_permlane16_swap_b32 v246, v245
    v_pk_fma_f32 v[150:151], v[150:151], s[46:47], v[240:241] op_sel_hi:[1,0,0] neg_lo:[0,0,1] neg_hi:[0,0,1]
    v_exp_f32 v148, v148
    v_exp_f32 v149, v149
    s_add_u32 m0, s4, 4096
    s_nop 0
    buffer_load_dwordx4 v251, s[16:19], s7 offen offset:3072 nt lds
    v_pk_fma_f32 v[152:153], v[152:153], s[46:47], v[240:241] op_sel_hi:[1,0,0] neg_lo:[0,0,1] neg_hi:[0,0,1]
    v_exp_f32 v150, v150
    v_exp_f32 v151, v151
    v_pk_add_f32 v[242:243], v[144:145], v[146:147]
    v_add_f32 v246, v246, v245
    v_pk_fma_f32 v[154:155], v[154:155], s[46:47], v[240:241] op_sel_hi:[1,0,0] neg_lo:[0,0,1] neg_hi:[0,0,1]
    v_exp_f32 v152, v152
    v_exp_f32 v153, v153
    v_pk_add_f32 v[242:243], v[242:243], v[148:149]
    v_rcp_f32 v246, v246
    v_accvgpr_read_b32 v206, a8
    v_accvgpr_read_b32 v207, a12
    v_pk_fma_f32 v[156:157], v[156:157], s[46:47], v[240:241] op_sel_hi:[1,0,0] neg_lo:[0,0,1] neg_hi:[0,0,1]
    v_exp_f32 v154, v154
    v_exp_f32 v155, v155
    v_pk_add_f32 v[242:243], v[242:243], v[150:151]
    v_cvt_pk_bf16_f32 v128, v174, v175
    v_cvt_pk_bf16_f32 v129, v206, v207
    v_pk_fma_f32 v[158:159], v[158:159], s[46:47], v[240:241] op_sel_hi:[1,0,0] neg_lo:[0,0,1] neg_hi:[0,0,1]
    v_exp_f32 v156, v156
    v_exp_f32 v157, v157
    v_pk_add_f32 v[242:243], v[242:243], v[152:153]
    v_pk_mul_f32 v[176:177], v[176:177], v[246:247] op_sel_hi:[1,0]
    v_pk_mul_f32 v[178:179], v[178:179], v[246:247] op_sel_hi:[1,0]
    v_accvgpr_read_b32 v174, a16
    v_accvgpr_read_b32 v175, a20
    v_accvgpr_read_b32 v206, a24
    v_accvgpr_read_b32 v207, a28
    v_pk_fma_f32 v[160:161], v[160:161], s[46:47], v[240:241] op_sel_hi:[1,0,0] neg_lo:[0,0,1] neg_hi:[0,0,1]
    v_exp_f32 v158, v158
    v_exp_f32 v159, v159
    v_pk_add_f32 v[242:243], v[242:243], v[154:155]
    v_cvt_pk_bf16_f32 v196, v176, v177
    v_cvt_pk_bf16_f32 v197, v178, v179
    v_pk_mul_f32 v[180:181], v[180:181], v[246:247] op_sel_hi:[1,0]
    v_pk_mul_f32 v[182:183], v[182:183], v[246:247] op_sel_hi:[1,0]
    v_cvt_pk_bf16_f32 v130, v174, v175
    v_cvt_pk_bf16_f32 v131, v206, v207
    v_pk_fma_f32 v[162:163], v[162:163], s[46:47], v[240:241] op_sel_hi:[1,0,0] neg_lo:[0,0,1] neg_hi:[0,0,1]
    v_exp_f32 v160, v160
    v_mfma_f32_16x16x32_bf16 v[176:179], a[104:107], v[128:131], 0
    v_exp_f32 v161, v161
    v_add_f32 v242, v242, v156
    v_add_f32 v243, v243, v157
    v_cvt_pk_bf16_f32 v198, v180, v181
    v_cvt_pk_bf16_f32 v199, v182, v183
    v_mfma_f32_16x16x32_bf16 v[180:183], a[120:123], v[128:131], 0
    s_add_u32 m0, s4, 8192
    v_mul_f32 v184, v184, v246
    buffer_load_dwordx4 v248, s[24:27], 0 offen  lds
    v_mul_f32 v185, v185, v246
    v_pk_mul_f32 v[186:187], v[186:187], v[246:247] op_sel_hi:[1,0]
    v_accvgpr_read_b32 v174, a1
    v_accvgpr_read_b32 v175, a5
    v_accvgpr_read_b32 v206, a9
    v_accvgpr_read_b32 v207, a13
    v_exp_f32 v162, v162
    v_exp_f32 v163, v163
    v_pk_add_f32 v[242:243], v[242:243], v[158:159]
    v_cvt_pk_bf16_f32 v200, v184, v185
    v_cvt_pk_bf16_f32 v201, v186, v187
    v_mfma_f32_16x16x32_bf16 v[184:187], a[136:139], v[128:131], 0
    v_mul_f32 v188, v188, v246
    v_mul_f32 v189, v189, v246
    v_mul_f32 v190, v190, v246
    v_mul_f32 v191, v191, v246
    v_cvt_pk_bf16_f32 v132, v174, v175
    v_cvt_pk_bf16_f32 v133, v206, v207
    v_pk_add_f32 v[242:243], v[242:243], v[160:161]
    v_cvt_pk_bf16_f32 v202, v188, v189
    v_cvt_pk_bf16_f32 v203, v190, v191
    v_mfma_f32_16x16x32_bf16 v[188:191], a[152:155], v[128:131], 0
    v_mul_f32 v192, v192, v246
    v_mul_f32 v193, v193, v246
    v_mul_f32 v194, v194, v246
    v_mul_f32 v195, v195, v246
    v_accvgpr_read_b32 v174, a17
    v_accvgpr_read_b32 v175, a21
    v_accvgpr_read_b32 v206, a25
    v_accvgpr_read_b32 v207, a29
    v_pk_add_f32 v[242:243], v[242:243], v[162:163]
    v_cvt_pk_bf16_f32 v204, v192, v193
    v_cvt_pk_bf16_f32 v205, v194, v195
    v_mfma_f32_16x16x32_bf16 v[192:195], a[168:171], v[128:131], 0
    v_cvt_pk_bf16_f32 v134, v174, v175
    v_cvt_pk_bf16_f32 v135, v206, v207
    v_add_f32 v242, v242, v243
    v_accvgpr_read_b32 v174, a2
    v_mfma_f32_16x16x32_bf16 v[176:179], a[108:111], v[132:135], v[176:179]
    v_accvgpr_read_b32 v175, a6
    v_accvgpr_read_b32 v206, a10
    v_mfma_f32_16x16x32_bf16 v[180:183], a[124:127], v[132:135], v[180:183]
    v_accvgpr_read_b32 v207, a14
    v_mov_b32 v241, v242
    v_mfma_f32_16x16x32_bf16 v[184:187], a[140:143], v[132:135], v[184:187]
    v_cvt_pk_bf16_f32 v136, v174, v175
    v_cvt_pk_bf16_f32 v137, v206, v207
    v_mfma_f32_16x16x32_bf16 v[188:191], a[156:159], v[132:135], v[188:191]
    v_permlane32_swap_b32 v242, v241
    v_mfma_f32_16x16x32_bf16 v[192:195], a[172:175], v[132:135], v[192:195]
    s_add_u32 m0, s4, 9216
    v_accvgpr_read_b32 v174, a18
    buffer_load_dwordx4 v248, s[24:27], s37 offen  lds
    v_accvgpr_read_b32 v175, a22
    v_accvgpr_read_b32 v206, a26
    v_accvgpr_read_b32 v207, a30
    v_cvt_pk_bf16_f32 v138, v174, v175
    v_cvt_pk_bf16_f32 v139, v206, v207
    v_add_f32 v242, v242, v241
    v_accvgpr_read_b32 v174, a3
    v_mfma_f32_16x16x32_bf16 v[176:179], a[112:115], v[136:139], v[176:179]
    v_accvgpr_read_b32 v175, a7
    v_accvgpr_read_b32 v206, a11
    v_mfma_f32_16x16x32_bf16 v[180:183], a[128:131], v[136:139], v[180:183]
    v_accvgpr_read_b32 v207, a15
    v_mov_b32 v241, v242
    v_mfma_f32_16x16x32_bf16 v[184:187], a[144:147], v[136:139], v[184:187]
    v_cvt_pk_bf16_f32 v140, v174, v175
    v_cvt_pk_bf16_f32 v141, v206, v207
    v_mfma_f32_16x16x32_bf16 v[188:191], a[160:163], v[136:139], v[188:191]
    v_permlane16_swap_b32 v242, v241
    v_mfma_f32_16x16x32_bf16 v[192:195], a[176:179], v[136:139], v[192:195]
    v_accvgpr_read_b32 v174, a19
    v_accvgpr_read_b32 v175, a23
    v_accvgpr_read_b32 v206, a27
    v_accvgpr_read_b32 v207, a31
    v_cvt_pk_bf16_f32 v142, v174, v175
    v_cvt_pk_bf16_f32 v143, v206, v207
    v_add_f32 v242, v242, v241
    v_rcp_f32 v242, v242
    v_mfma_f32_16x16x32_bf16 v[176:179], a[116:119], v[140:143], v[176:179]
    v_accvgpr_read_b32 v174, a32
    v_accvgpr_read_b32 v175, a36
    v_mfma_f32_16x16x32_bf16 v[180:183], a[132:135], v[140:143], v[180:183]
    v_accvgpr_read_b32 v206, a40
    v_accvgpr_read_b32 v207, a44
    v_mfma_f32_16x16x32_bf16 v[184:187], a[148:151], v[140:143], v[184:187]
    v_cvt_pk_bf16_f32 v112, v174, v175
    v_cvt_pk_bf16_f32 v113, v206, v207
    v_mfma_f32_16x16x32_bf16 v[188:191], a[164:167], v[140:143], v[188:191]
    v_mul_f32 v144, v144, v242
    v_mul_f32 v145, v145, v242
    v_mfma_f32_16x16x32_bf16 v[192:195], a[180:183], v[140:143], v[192:195]
    v_mul_f32 v146, v146, v242
    v_mul_f32 v147, v147, v242
    v_accvgpr_read_b32 v174, a48
    v_accvgpr_read_b32 v175, a52
    v_accvgpr_read_b32 v206, a56
    s_add_u32 m0, s4, 10240
    s_nop 0
    buffer_load_dwordx4 v248, s[24:27], s38 offen  lds
    v_accvgpr_read_b32 v207, a60
    v_cvt_pk_bf16_f32 v208, v144, v145
    v_cvt_pk_bf16_f32 v209, v146, v147
    v_pk_mul_f32 v[148:149], v[148:149], v[242:243] op_sel_hi:[1,0]
    v_pk_mul_f32 v[150:151], v[150:151], v[242:243] op_sel_hi:[1,0]
    v_cvt_pk_bf16_f32 v114, v174, v175
    v_cvt_pk_bf16_f32 v115, v206, v207
    v_cvt_pk_bf16_f32 v210, v148, v149
    v_cvt_pk_bf16_f32 v211, v150, v151
    v_mfma_f32_16x16x32_bf16 v[144:147], a[104:107], v[112:115], 0
    v_mul_f32 v152, v152, v242
    v_mul_f32 v153, v153, v242
    v_mfma_f32_16x16x32_bf16 v[148:151], a[120:123], v[112:115], 0
    v_mul_f32 v154, v154, v242
    v_mul_f32 v155, v155, v242
    v_accvgpr_read_b32 v174, a33
    v_accvgpr_read_b32 v175, a37
    v_accvgpr_read_b32 v206, a41
    v_accvgpr_read_b32 v207, a45
    v_cvt_pk_bf16_f32 v212, v152, v153
    v_cvt_pk_bf16_f32 v213, v154, v155
    v_mfma_f32_16x16x32_bf16 v[152:155], a[136:139], v[112:115], 0
    v_mul_f32 v156, v156, v242
    v_mul_f32 v157, v157, v242
    v_mul_f32 v158, v158, v242
    v_mul_f32 v159, v159, v242
    v_cvt_pk_bf16_f32 v116, v174, v175
    v_cvt_pk_bf16_f32 v117, v206, v207
    v_cvt_pk_bf16_f32 v214, v156, v157
    v_cvt_pk_bf16_f32 v215, v158, v159
    v_mfma_f32_16x16x32_bf16 v[156:159], a[152:155], v[112:115], 0
    v_mul_f32 v160, v160, v242
    v_mul_f32 v161, v161, v242
    v_mul_f32 v162, v162, v242
    v_mul_f32 v163, v163, v242
    v_accvgpr_read_b32 v174, a49
    v_accvgpr_read_b32 v175, a53
    v_accvgpr_read_b32 v206, a57
    v_accvgpr_read_b32 v207, a61
    v_cvt_pk_bf16_f32 v216, v160, v161
    v_cvt_pk_bf16_f32 v217, v162, v163
    v_mfma_f32_16x16x32_bf16 v[160:163], a[168:171], v[112:115], 0
    v_cvt_pk_bf16_f32 v118, v174, v175
    v_cvt_pk_bf16_f32 v119, v206, v207
    v_accvgpr_read_b32 v174, a34
    v_accvgpr_read_b32 v175, a38
    v_mfma_f32_16x16x32_bf16 v[144:147], a[108:111], v[116:119], v[144:147]
    v_accvgpr_read_b32 v206, a42
    v_accvgpr_read_b32 v207, a46
    v_mfma_f32_16x16x32_bf16 v[148:151], a[124:127], v[116:119], v[148:151]
    v_cvt_pk_bf16_f32 v120, v174, v175
    v_cvt_pk_bf16_f32 v121, v206, v207
    v_mfma_f32_16x16x32_bf16 v[152:155], a[140:143], v[116:119], v[152:155]
    v_accvgpr_read_b32 v174, a50
    s_add_u32 m0, s4, 11264
    v_mfma_f32_16x16x32_bf16 v[156:159], a[156:159], v[116:119], v[156:159]
    buffer_load_dwordx4 v248, s[24:27], s39 offen  lds
    v_add_u32 v248, 0x8000, v248
    v_mfma_f32_16x16x32_bf16 v[160:163], a[172:175], v[116:119], v[160:163]
    v_and_b32 v248, 0x7ffff, v248
    v_accvgpr_read_b32 v175, a54
    v_accvgpr_read_b32 v206, a58
    v_accvgpr_read_b32 v207, a62
    v_cvt_pk_bf16_f32 v122, v174, v175
    v_cvt_pk_bf16_f32 v123, v206, v207
    v_accvgpr_read_b32 v174, a35
    v_accvgpr_read_b32 v175, a39
    v_mfma_f32_16x16x32_bf16 v[144:147], a[112:115], v[120:123], v[144:147]
    v_accvgpr_read_b32 v206, a43
    v_accvgpr_read_b32 v207, a47
    v_mfma_f32_16x16x32_bf16 v[148:151], a[128:131], v[120:123], v[148:151]
    v_cvt_pk_bf16_f32 v124, v174, v175
    v_cvt_pk_bf16_f32 v125, v206, v207
    v_mfma_f32_16x16x32_bf16 v[152:155], a[144:147], v[120:123], v[152:155]
    v_max3_f32 v244, v176, v177, v178
    v_accvgpr_read_b32 v174, a51
    v_mfma_f32_16x16x32_bf16 v[156:159], a[160:163], v[120:123], v[156:159]
    v_accvgpr_read_b32 v175, a55
    v_accvgpr_read_b32 v206, a59
    v_mfma_f32_16x16x32_bf16 v[160:163], a[176:179], v[120:123], v[160:163]
    v_accvgpr_read_b32 v207, a63
    v_max3_f32 v245, v179, v180, v181
    v_max3_f32 v244, v244, v182, v183
    v_cvt_pk_bf16_f32 v126, v174, v175
    v_cvt_pk_bf16_f32 v127, v206, v207
    v_max3_f32 v245, v245, v184, v185
    v_max3_f32 v244, v244, v186, v187
    v_mfma_f32_16x16x32_bf16 v[144:147], a[116:119], v[124:127], v[144:147]
    v_max3_f32 v245, v245, v188, v189
    v_max3_f32 v244, v244, v190, v191
    v_mfma_f32_16x16x32_bf16 v[148:151], a[132:135], v[124:127], v[148:151]
    v_max3_f32 v245, v245, v192, v193
    v_max3_f32 v244, v244, v194, v195
    v_mfma_f32_16x16x32_bf16 v[152:155], a[148:151], v[124:127], v[152:155]
    v_max_f32 v244, v244, v245
    v_mov_b32 v246, v244
    v_mfma_f32_16x16x32_bf16 v[156:159], a[164:167], v[124:127], v[156:159]
    v_max3_f32 v240, v144, v145, v146
    v_permlane32_swap_b32 v244, v246
    v_mfma_f32_16x16x32_bf16 v[160:163], a[180:183], v[124:127], v[160:163]
    v_max_f32 v244, v244, v246
    v_mov_b32 v246, v244
    v_max3_f32 v241, v147, v148, v149
    v_max3_f32 v240, v240, v150, v151
    s_add_u32 m0, s4, 12288
    s_nop 0
    buffer_load_dwordx4 v248, s[24:27], 0 offen  lds
    v_permlane16_swap_b32 v244, v246
    v_max_f32 v244, v244, v246
    v_mul_f32 v244, s46, v244
    v_pk_fma_f32 v[176:177], v[176:177], s[46:47], v[244:245] op_sel_hi:[1,0,0] neg_lo:[0,0,1] neg_hi:[0,0,1]
    v_pk_fma_f32 v[178:179], v[178:179], s[46:47], v[244:245] op_sel_hi:[1,0,0] neg_lo:[0,0,1] neg_hi:[0,0,1]
    v_pk_fma_f32 v[180:181], v[180:181], s[46:47], v[244:245] op_sel_hi:[1,0,0] neg_lo:[0,0,1] neg_hi:[0,0,1]
    v_exp_f32 v176, v176
    v_exp_f32 v177, v177
    v_exp_f32 v178, v178
    v_exp_f32 v179, v179
    v_pk_fma_f32 v[182:183], v[182:183], s[46:47], v[244:245] op_sel_hi:[1,0,0] neg_lo:[0,0,1] neg_hi:[0,0,1]
    v_exp_f32 v180, v180
    v_exp_f32 v181, v181
    v_pk_fma_f32 v[184:185], v[184:185], s[46:47], v[244:245] op_sel_hi:[1,0,0] neg_lo:[0,0,1] neg_hi:[0,0,1]
    v_exp_f32 v182, v182
    v_exp_f32 v183, v183
    v_pk_add_f32 v[246:247], v[176:177], v[178:179]
    v_max3_f32 v241, v241, v152, v153
    v_max3_f32 v240, v240, v154, v155
    v_pk_fma_f32 v[186:187], v[186:187], s[46:47], v[244:245] op_sel_hi:[1,0,0] neg_lo:[0,0,1] neg_hi:[0,0,1]
    v_exp_f32 v184, v184
    v_exp_f32 v185, v185
    v_pk_add_f32 v[246:247], v[246:247], v[180:181]
    v_max3_f32 v241, v241, v156, v157
    v_max3_f32 v240, v240, v158, v159
    v_pk_fma_f32 v[188:189], v[188:189], s[46:47], v[244:245] op_sel_hi:[1,0,0] neg_lo:[0,0,1] neg_hi:[0,0,1]
    v_exp_f32 v186, v186
    v_exp_f32 v187, v187
    v_pk_add_f32 v[246:247], v[246:247], v[182:183]
    v_max3_f32 v241, v241, v160, v161
    v_max3_f32 v240, v240, v162, v163
    v_pk_fma_f32 v[190:191], v[190:191], s[46:47], v[244:245] op_sel_hi:[1,0,0] neg_lo:[0,0,1] neg_hi:[0,0,1]
    v_exp_f32 v188, v188
    v_exp_f32 v189, v189
    v_pk_add_f32 v[246:247], v[246:247], v[184:185]
    v_max_f32 v240, v240, v241
    v_pk_fma_f32 v[192:193], v[192:193], s[46:47], v[244:245] op_sel_hi:[1,0,0] neg_lo:[0,0,1] neg_hi:[0,0,1]
    v_exp_f32 v190, v190
    v_exp_f32 v191, v191
    v_pk_add_f32 v[246:247], v[246:247], v[186:187]
    v_mov_b32 v242, v240
    v_pk_fma_f32 v[194:195], v[194:195], s[46:47], v[244:245] op_sel_hi:[1,0,0] neg_lo:[0,0,1] neg_hi:[0,0,1]
    v_exp_f32 v192, v192
    s_add_u32 m0, s4, 13312
    s_nop 0
    buffer_load_dwordx4 v248, s[24:27], s37 offen  lds
    v_exp_f32 v193, v193
    v_pk_add_f32 v[246:247], v[246:247], v[188:189]
    v_permlane32_swap_b32 v240, v242
    v_exp_f32 v194, v194
    v_exp_f32 v195, v195
    v_pk_add_f32 v[246:247], v[246:247], v[190:191]
    v_pk_add_f32 v[246:247], v[246:247], v[192:193]
    v_max_f32 v240, v240, v242
    v_pk_add_f32 v[246:247], v[246:247], v[194:195]
    v_mov_b32 v242, v240
    v_add_f32 v246, v246, v247
    v_mov_b32 v245, v246
    v_permlane16_swap_b32 v240, v242
    v_max_f32 v240, v240, v242
    v_permlane32_swap_b32 v246, v245
    v_mul_f32 v240, s46, v240
    v_add_f32 v246, v246, v245
    v_pk_fma_f32 v[144:145], v[144:145], s[46:47], v[240:241] op_sel_hi:[1,0,0] neg_lo:[0,0,1] neg_hi:[0,0,1]
    v_pk_fma_f32 v[146:147], v[146:147], s[46:47], v[240:241] op_sel_hi:[1,0,0] neg_lo:[0,0,1] neg_hi:[0,0,1]
    v_mov_b32 v245, v246
    v_pk_fma_f32 v[148:149], v[148:149], s[46:47], v[240:241] op_sel_hi:[1,0,0] neg_lo:[0,0,1] neg_hi:[0,0,1]
    v_exp_f32 v144, v144
    v_exp_f32 v145, v145
    v_exp_f32 v146, v146
    v_exp_f32 v147, v147
    v_permlane16_swap_b32 v246, v245
    v_pk_fma_f32 v[150:151], v[150:151], s[46:47], v[240:241] op_sel_hi:[1,0,0] neg_lo:[0,0,1] neg_hi:[0,0,1]
    v_exp_f32 v148, v148
    v_exp_f32 v149, v149
    v_pk_fma_f32 v[152:153], v[152:153], s[46:47], v[240:241] op_sel_hi:[1,0,0] neg_lo:[0,0,1] neg_hi:[0,0,1]
    v_exp_f32 v150, v150
    v_exp_f32 v151, v151
    v_pk_add_f32 v[242:243], v[144:145], v[146:147]
    v_add_f32 v246, v246, v245
    v_pk_fma_f32 v[154:155], v[154:155], s[46:47], v[240:241] op_sel_hi:[1,0,0] neg_lo:[0,0,1] neg_hi:[0,0,1]
    v_exp_f32 v152, v152
    v_exp_f32 v153, v153
    v_pk_add_f32 v[242:243], v[242:243], v[148:149]
    v_rcp_f32 v246, v246
    v_pk_fma_f32 v[156:157], v[156:157], s[46:47], v[240:241] op_sel_hi:[1,0,0] neg_lo:[0,0,1] neg_hi:[0,0,1]
    v_exp_f32 v154, v154
    s_add_u32 m0, s4, 14336
    s_nop 0
    buffer_load_dwordx4 v248, s[24:27], s38 offen  lds
    s_waitcnt vmcnt(7)
    ds_read_b64_tr_b16 a[64:65], v4 offset:0
    ds_read_b64_tr_b16 a[66:67], v4 offset:16384
    ds_read_b64_tr_b16 a[68:69], v4 offset:32768
    ds_read_b64_tr_b16 a[70:71], v5 offset:0
    ds_read_b64_tr_b16 a[72:73], v5 offset:4096
    v_xor_b32 v4, 32, v4
    v_xor_b32 v5, 32, v5
    v_exp_f32 v155, v155
    v_pk_add_f32 v[242:243], v[242:243], v[150:151]
    v_pk_fma_f32 v[158:159], v[158:159], s[46:47], v[240:241] op_sel_hi:[1,0,0] neg_lo:[0,0,1] neg_hi:[0,0,1]
    v_exp_f32 v156, v156
    v_exp_f32 v157, v157
    v_pk_add_f32 v[242:243], v[242:243], v[152:153]
    v_pk_mul_f32 v[176:177], v[176:177], v[246:247] op_sel_hi:[1,0]
    v_pk_mul_f32 v[178:179], v[178:179], v[246:247] op_sel_hi:[1,0]
    v_pk_mul_f32 v[180:181], v[180:181], v[246:247] op_sel_hi:[1,0]
    v_pk_mul_f32 v[182:183], v[182:183], v[246:247] op_sel_hi:[1,0]
    v_pk_fma_f32 v[160:161], v[160:161], s[46:47], v[240:241] op_sel_hi:[1,0,0] neg_lo:[0,0,1] neg_hi:[0,0,1]
    v_exp_f32 v158, v158
    v_exp_f32 v159, v159
    v_pk_add_f32 v[242:243], v[242:243], v[154:155]
    v_cvt_pk_bf16_f32 v218, v176, v177
    v_cvt_pk_bf16_f32 v219, v178, v179
    s_waitcnt lgkmcnt(0)
    v_mfma_f32_16x16x32_bf16 v[16:19], a[64:67], v[164:167], 0
    ds_read_b64_tr_b16 a[74:75], v4 offset:0
    ds_read_b64_tr_b16 a[76:77], v4 offset:16384
    v_mfma_f32_16x16x32_bf16 v[16:19], a[68:71], v[168:171], v[16:19]
    ds_read_b64_tr_b16 a[78:79], v4 offset:32768
    ds_read_b64_tr_b16 a[80:81], v5 offset:0
    v_mfma_f32_16x16x32_bf16 v[48:51], a[64:67], v[196:199], 0
    ds_read_b64_tr_b16 a[82:83], v5 offset:4096
    v_xor_b32 v4, 96, v4
    v_mfma_f32_16x16x32_bf16 v[48:51], a[68:71], v[200:203], v[48:51]
    ds_read_b64_tr_b16 a[84:85], v4 offset:0
    ds_read_b64_tr_b16 a[86:87], v4 offset:16384
    v_mfma_f32_16x16x16_bf16 v[16:19], a[72:73], v[172:173], v[16:19]
    ds_read_b64_tr_b16 a[88:89], v4 offset:32768
    v_xor_b32 v5, 96, v5
    v_xor_b32 v4, 32, v4
    v_mfma_f32_16x16x16_bf16 v[48:51], a[72:73], v[204:205], v[48:51]
    ds_read_b64_tr_b16 a[90:91], v5 offset:0
    ds_read_b64_tr_b16 a[92:93], v5 offset:4096
    ds_read_b64_tr_b16 a[94:95], v4 offset:0
    ds_read_b64_tr_b16 a[96:97], v4 offset:16384
    ds_read_b64_tr_b16 a[98:99], v4 offset:32768
    v_xor_b32 v5, 32, v5
    v_xor_b32 v4, 224, v4
    s_waitcnt lgkmcnt(8)
    v_mfma_f32_16x16x32_bf16 v[20:23], a[74:77], v[164:167], 0
    ds_read_b64_tr_b16 a[100:101], v5 offset:0
    s_add_u32 m0, s4, 15360
    v_mfma_f32_16x16x32_bf16 v[20:23], a[78:81], v[168:171], v[20:23]
    buffer_load_dwordx4 v248, s[24:27], s39 offen  lds
    v_add_u32 v248, 0x8000, v248
    v_mfma_f32_16x16x32_bf16 v[52:55], a[74:77], v[196:199], 0
    v_and_b32 v248, 0x7ffff, v248
    v_cvt_pk_bf16_f32 v80, v16, v17
    s_waitcnt lgkmcnt(5)
    v_mfma_f32_16x16x32_bf16 v[24:27], a[84:87], v[164:167], 0
    ds_read_b64_tr_b16 a[102:103], v5 offset:4096
    ds_read_b64_tr_b16 a[184:185], v4 offset:0
    v_mfma_f32_16x16x16_bf16 v[20:23], a[82:83], v[172:173], v[20:23]
    ds_read_b64_tr_b16 a[186:187], v4 offset:16384
    ds_read_b64_tr_b16 a[188:189], v4 offset:32768
    v_mfma_f32_16x16x32_bf16 v[24:27], a[88:91], v[168:171], v[24:27]
    v_xor_b32 v5, 224, v5
    v_xor_b32 v4, 32, v4
    s_waitcnt lgkmcnt(4)
    v_mfma_f32_16x16x32_bf16 v[28:31], a[94:97], v[164:167], 0
    ds_read_b64_tr_b16 a[190:191], v5 offset:0
    ds_read_b64_tr_b16 a[192:193], v5 offset:4096
    v_mfma_f32_16x16x32_bf16 v[52:55], a[78:81], v[200:203], v[52:55]
    ds_read_b64_tr_b16 a[194:195], v4 offset:0
    ds_read_b64_tr_b16 a[196:197], v4 offset:16384
    v_mfma_f32_16x16x32_bf16 v[28:31], a[98:101], v[168:171], v[28:31]
    ds_read_b64_tr_b16 a[198:199], v4 offset:32768
    v_xor_b32 v5, 32, v5
    v_mfma_f32_16x16x16_bf16 v[24:27], a[92:93], v[172:173], v[24:27]
    ds_read_b64_tr_b16 a[200:201], v5 offset:0
    ds_read_b64_tr_b16 a[202:203], v5 offset:4096
    v_mfma_f32_16x16x32_bf16 v[56:59], a[84:87], v[196:199], 0
    v_xor_b32 v4, 96, v4
    v_xor_b32 v5, 96, v5
    s_waitcnt lgkmcnt(7)
    v_mfma_f32_16x16x16_bf16 v[28:31], a[102:103], v[172:173], v[28:31]
    ds_read_b64_tr_b16 a[204:205], v4 offset:0
    ds_read_b64_tr_b16 a[206:207], v4 offset:16384
    v_mfma_f32_16x16x32_bf16 v[32:35], a[184:187], v[164:167], 0
    ds_read_b64_tr_b16 a[208:209], v4 offset:32768
    ds_read_b64_tr_b16 a[210:211], v5 offset:0
    v_mfma_f32_16x16x32_bf16 v[60:63], a[94:97], v[196:199], 0
    ds_read_b64_tr_b16 a[212:213], v5 offset:4096
    v_xor_b32 v4, 32, v4
    s_waitcnt lgkmcnt(7)
    v_mfma_f32_16x16x32_bf16 v[32:35], a[188:191], v[168:171], v[32:35]
    ds_read_b64_tr_b16 a[214:215], v4 offset:0
    ds_read_b64_tr_b16 a[216:217], v4 offset:16384
    v_mfma_f32_16x16x32_bf16 v[36:39], a[194:197], v[164:167], 0
    ds_read_b64_tr_b16 a[218:219], v4 offset:32768
    v_xor_b32 v5, 32, v5
    v_mfma_f32_16x16x16_bf16 v[52:55], a[82:83], v[204:205], v[52:55]
    ds_read_b64_tr_b16 a[220:221], v5 offset:0
    ds_read_b64_tr_b16 a[222:223], v5 offset:4096
    s_waitcnt lgkmcnt(8)
    v_mfma_f32_16x16x32_bf16 v[36:39], a[198:201], v[168:171], v[36:39]
    v_cvt_pk_bf16_f32 v81, v18, v19
    v_cvt_pk_bf16_f32 v82, v20, v21
    v_mfma_f32_16x16x16_bf16 v[32:35], a[192:193], v[172:173], v[32:35]
    v_cvt_pk_bf16_f32 v83, v22, v23
    v_cvt_pk_bf16_f32 v84, v24, v25
    v_mfma_f32_16x16x32_bf16 v[40:43], a[204:207], v[164:167], 0
    v_cvt_pk_bf16_f32 v85, v26, v27
    v_cvt_pk_bf16_f32 v86, v28, v29
    v_mfma_f32_16x16x16_bf16 v[36:39], a[202:203], v[172:173], v[36:39]
    v_cvt_pk_bf16_f32 v87, v30, v31
    v_cvt_pk_bf16_f32 v220, v180, v181
    s_waitcnt lgkmcnt(2)
    v_mfma_f32_16x16x32_bf16 v[40:43], a[208:211], v[168:171], v[40:43]
    v_cvt_pk_bf16_f32 v221, v182, v183
    v_fma_f32 v162, v162, s46, -v240
    v_mfma_f32_16x16x32_bf16 v[44:47], a[214:217], v[164:167], 0
    v_fma_f32 v163, v163, s46, -v240
    v_exp_f32 v160, v160
    s_waitcnt lgkmcnt(0)
    v_mfma_f32_16x16x32_bf16 v[44:47], a[218:221], v[168:171], v[44:47]
    s_barrier
    ds_write_b128 v249, v[80:83] offset:0
    v_mfma_f32_16x16x16_bf16 v[40:43], a[212:213], v[172:173], v[40:43]
    ds_write_b128 v6, v[84:87] offset:0
    v_mfma_f32_16x16x32_bf16 v[56:59], a[88:91], v[200:203], v[56:59]
    v_cvt_pk_bf16_f32 v80, v32, v33
    v_cvt_pk_bf16_f32 v81, v34, v35
    v_mfma_f32_16x16x16_bf16 v[44:47], a[222:223], v[172:173], v[44:47]
    v_cvt_pk_bf16_f32 v82, v36, v37
    v_cvt_pk_bf16_f32 v83, v38, v39
    v_mfma_f32_16x16x32_bf16 v[60:63], a[98:101], v[200:203], v[60:63]
    ds_write_b128 v7, v[80:83] offset:0
    v_mfma_f32_16x16x32_bf16 v[64:67], a[184:187], v[196:199], 0
    v_cvt_pk_bf16_f32 v84, v40, v41
    v_cvt_pk_bf16_f32 v85, v42, v43
    v_mfma_f32_16x16x32_bf16 v[68:71], a[194:197], v[196:199], 0
    v_cvt_pk_bf16_f32 v86, v44, v45
    v_cvt_pk_bf16_f32 v87, v46, v47
    v_mfma_f32_16x16x16_bf16 v[56:59], a[92:93], v[204:205], v[56:59]
    ds_write_b128 v1, v[84:87] offset:0
    v_mfma_f32_16x16x16_bf16 v[60:63], a[102:103], v[204:205], v[60:63]
    v_cvt_pk_bf16_f32 v80, v48, v49
    v_cvt_pk_bf16_f32 v81, v50, v51
    v_mfma_f32_16x16x32_bf16 v[64:67], a[188:191], v[200:203], v[64:67]
    s_add_u32 m0, s4, 16384
    v_cvt_pk_bf16_f32 v82, v52, v53
    v_mfma_f32_16x16x32_bf16 v[68:71], a[198:201], v[200:203], v[68:71]
    buffer_load_dwordx4 v248, s[24:27], 0 offen  lds
    v_cvt_pk_bf16_f32 v83, v54, v55
    v_mfma_f32_16x16x32_bf16 v[72:75], a[204:207], v[196:199], 0
    ds_write_b128 v249, v[80:83] offset:1024
    v_mfma_f32_16x16x32_bf16 v[76:79], a[214:217], v[196:199], 0
    v_cvt_pk_bf16_f32 v84, v56, v57
    v_cvt_pk_bf16_f32 v85, v58, v59
    v_mfma_f32_16x16x16_bf16 v[64:67], a[192:193], v[204:205], v[64:67]
    v_cvt_pk_bf16_f32 v86, v60, v61
    v_cvt_pk_bf16_f32 v87, v62, v63
    v_mfma_f32_16x16x16_bf16 v[68:71], a[202:203], v[204:205], v[68:71]
    s_add_u32 m0, s4, 17408
    ds_write_b128 v6, v[84:87] offset:1024
    v_mfma_f32_16x16x32_bf16 v[72:75], a[208:211], v[200:203], v[72:75]
    buffer_load_dwordx4 v248, s[24:27], s37 offen  lds
    v_exp_f32 v161, v161
    v_mfma_f32_16x16x32_bf16 v[76:79], a[218:221], v[200:203], v[76:79]
    v_cvt_pk_bf16_f32 v80, v64, v65
    v_cvt_pk_bf16_f32 v81, v66, v67
    v_mfma_f32_16x16x32_bf16 v[16:19], a[64:67], v[208:211], 0
    v_cvt_pk_bf16_f32 v82, v68, v69
    v_cvt_pk_bf16_f32 v83, v70, v71
    v_mfma_f32_16x16x32_bf16 v[20:23], a[74:77], v[208:211], 0
    s_add_u32 m0, s4, 18432
    ds_write_b128 v7, v[80:83] offset:1024
    v_mfma_f32_16x16x16_bf16 v[72:75], a[212:213], v[204:205], v[72:75]
    buffer_load_dwordx4 v248, s[24:27], s38 offen  lds
    v_add_f32 v242, v242, v156
    v_mfma_f32_16x16x16_bf16 v[76:79], a[222:223], v[204:205], v[76:79]
    v_add_f32 v243, v243, v157
    v_exp_f32 v162, v162
    v_mfma_f32_16x16x32_bf16 v[16:19], a[68:71], v[212:215], v[16:19]
    v_exp_f32 v163, v163
    v_mfma_f32_16x16x32_bf16 v[20:23], a[78:81], v[212:215], v[20:23]
    v_cvt_pk_bf16_f32 v84, v72, v73
    s_add_u32 m0, s4, 19456
    v_mfma_f32_16x16x32_bf16 v[24:27], a[84:87], v[208:211], 0
    buffer_load_dwordx4 v248, s[24:27], s39 offen  lds
    v_add_u32 v248, 0x8000, v248
    v_mfma_f32_16x16x32_bf16 v[28:31], a[94:97], v[208:211], 0
    v_and_b32 v248, 0x7ffff, v248
    v_cvt_pk_bf16_f32 v85, v74, v75
    v_mfma_f32_16x16x16_bf16 v[16:19], a[72:73], v[216:217], v[16:19]
    v_cvt_pk_bf16_f32 v86, v76, v77
    v_cvt_pk_bf16_f32 v87, v78, v79
    v_mfma_f32_16x16x16_bf16 v[20:23], a[82:83], v[216:217], v[20:23]
    ds_write_b128 v1, v[84:87] offset:1024
    v_mfma_f32_16x16x32_bf16 v[24:27], a[88:91], v[212:215], v[24:27]
    s_add_u32 m0, s4, 0
    v_add_f32 v242, v242, v158
    v_mfma_f32_16x16x32_bf16 v[28:31], a[98:101], v[212:215], v[28:31]
    buffer_load_dwordx4 v248, s[24:27], 0 offen  lds
    v_add_f32 v243, v243, v159
    v_mfma_f32_16x16x32_bf16 v[32:35], a[184:187], v[208:211], 0
    v_add_f32 v242, v242, v160
    v_add_f32 v243, v243, v161
    v_mfma_f32_16x16x32_bf16 v[36:39], a[194:197], v[208:211], 0
    v_cvt_pk_bf16_f32 v80, v16, v17
    v_cvt_pk_bf16_f32 v81, v18, v19
    v_mfma_f32_16x16x16_bf16 v[24:27], a[92:93], v[216:217], v[24:27]
    v_cvt_pk_bf16_f32 v82, v20, v21
    v_cvt_pk_bf16_f32 v83, v22, v23
    v_mfma_f32_16x16x16_bf16 v[28:31], a[102:103], v[216:217], v[28:31]
    ds_write_b128 v249, v[80:83] offset:2048
    v_mfma_f32_16x16x32_bf16 v[32:35], a[188:191], v[212:215], v[32:35]
    s_add_u32 m0, s4, 1024
    s_waitcnt vmcnt(9)
    ds_read_b64_tr_b16 v[176:177], v252 offset:8192
    v_mfma_f32_16x16x32_bf16 v[36:39], a[198:201], v[212:215], v[36:39]
    buffer_load_dwordx4 v248, s[24:27], s37 offen  lds
    ds_read_b64_tr_b16 v[178:179], v252 offset:10240
    v_mfma_f32_16x16x32_bf16 v[40:43], a[204:207], v[208:211], 0
    ds_read_b64_tr_b16 v[180:181], v253 offset:8192
    ds_read_b64_tr_b16 v[182:183], v253 offset:10240
    v_mfma_f32_16x16x32_bf16 v[44:47], a[214:217], v[208:211], 0
    v_mul_f32 v184, v184, v246
    v_mul_f32 v185, v185, v246
    v_mfma_f32_16x16x16_bf16 v[32:35], a[192:193], v[216:217], v[32:35]
    s_add_u32 m0, s4, 2048
    v_mul_f32 v186, v186, v246
    v_mfma_f32_16x16x16_bf16 v[36:39], a[202:203], v[216:217], v[36:39]
    buffer_load_dwordx4 v248, s[24:27], s38 offen  lds
    v_mul_f32 v187, v187, v246
    v_mfma_f32_16x16x32_bf16 v[40:43], a[208:211], v[212:215], v[40:43]
    v_mul_f32 v188, v188, v246
    v_mul_f32 v189, v189, v246
    v_mfma_f32_16x16x32_bf16 v[44:47], a[218:221], v[212:215], v[44:47]
    v_mul_f32 v190, v190, v246
    v_mul_f32 v191, v191, v246
    v_mfma_f32_16x16x32_bf16 v[112:115], a[64:67], v[218:221], 0
    v_add_f32 v242, v242, v162
    v_add_f32 v243, v243, v163
    v_mfma_f32_16x16x32_bf16 v[116:119], a[74:77], v[218:221], 0
    v_cvt_pk_bf16_f32 v222, v184, v185
    v_cvt_pk_bf16_f32 v223, v186, v187
    v_mfma_f32_16x16x16_bf16 v[40:43], a[212:213], v[216:217], v[40:43]
    s_add_u32 m0, s4, 3072
    ds_read_b64_tr_b16 v[184:185], v254 offset:8192
    v_mfma_f32_16x16x16_bf16 v[44:47], a[222:223], v[216:217], v[44:47]
    buffer_load_dwordx4 v248, s[24:27], s39 offen  lds
    v_add_u32 v248, 0x8000, v248
    v_mfma_f32_16x16x32_bf16 v[120:123], a[84:87], v[218:221], 0
    v_and_b32 v248, 0x7ffff, v248
    v_cvt_pk_bf16_f32 v224, v188, v189
    v_mfma_f32_16x16x32_bf16 v[124:127], a[94:97], v[218:221], 0
    ds_read_b64_tr_b16 v[186:187], v254 offset:10240
    ds_read_b64_tr_b16 v[188:189], v255 offset:8192
    v_mfma_f32_16x16x32_bf16 v[128:131], a[184:187], v[218:221], 0
    v_cvt_pk_bf16_f32 v225, v190, v191
    v_add_f32 v242, v242, v243
    v_mfma_f32_16x16x32_bf16 v[132:135], a[194:197], v[218:221], 0
    s_add_u32 m0, s4, 4096
    ds_read_b64_tr_b16 v[190:191], v255 offset:10240
    v_mfma_f32_16x16x32_bf16 v[112:115], a[68:71], v[222:225], v[112:115]
    buffer_load_dwordx4 v248, s[24:27], 0 offen  lds
    v_mov_b32 v241, v242
    v_mfma_f32_16x16x32_bf16 v[116:119], a[78:81], v[222:225], v[116:119]
    v_mul_f32 v192, v192, v246
    v_permlane32_swap_b32 v242, v241
    v_mfma_f32_16x16x32_bf16 v[120:123], a[88:91], v[222:225], v[120:123]
    v_mul_f32 v193, v193, v246
    v_mul_f32 v194, v194, v246
    v_mfma_f32_16x16x32_bf16 v[124:127], a[98:101], v[222:225], v[124:127]
    v_mul_f32 v195, v195, v246
    v_cvt_pk_bf16_f32 v84, v24, v25
    v_mfma_f32_16x16x32_bf16 v[128:131], a[188:191], v[222:225], v[128:131]
    s_add_u32 m0, s4, 5120
    v_cvt_pk_bf16_f32 v85, v26, v27
    v_mfma_f32_16x16x32_bf16 v[132:135], a[198:201], v[222:225], v[132:135]
    buffer_load_dwordx4 v248, s[24:27], s37 offen  lds
    v_cvt_pk_bf16_f32 v86, v28, v29
    v_mfma_f32_16x16x32_bf16 v[136:139], a[204:207], v[218:221], 0
    v_cvt_pk_bf16_f32 v87, v30, v31
    v_cvt_pk_bf16_f32 v226, v192, v193
    v_mfma_f32_16x16x32_bf16 v[140:143], a[214:217], v[218:221], 0
    ds_write_b128 v6, v[84:87] offset:2048
    v_mfma_f32_16x16x32_bf16 v[136:139], a[208:211], v[222:225], v[136:139]
    v_cvt_pk_bf16_f32 v227, v194, v195
    v_add_f32 v242, v242, v241
    v_mfma_f32_16x16x32_bf16 v[140:143], a[218:221], v[222:225], v[140:143]
    s_add_u32 m0, s4, 6144
    v_mov_b32 v241, v242
    v_mfma_f32_16x16x16_bf16 v[112:115], a[72:73], v[226:227], v[112:115]
    buffer_load_dwordx4 v248, s[24:27], s38 offen  lds
    v_permlane16_swap_b32 v242, v241
    v_mfma_f32_16x16x16_bf16 v[116:119], a[82:83], v[226:227], v[116:119]
    v_add_f32 v242, v242, v241
    v_cvt_pk_bf16_f32 v80, v32, v33
    v_mfma_f32_16x16x16_bf16 v[120:123], a[92:93], v[226:227], v[120:123]
    v_cvt_pk_bf16_f32 v81, v34, v35
    v_cvt_pk_bf16_f32 v82, v36, v37
    v_mfma_f32_16x16x16_bf16 v[124:127], a[102:103], v[226:227], v[124:127]
    v_cvt_pk_bf16_f32 v83, v38, v39
    v_rcp_f32 v242, v242
    v_mfma_f32_16x16x16_bf16 v[128:131], a[192:193], v[226:227], v[128:131]
    s_add_u32 m0, s4, 7168
    ds_write_b128 v7, v[80:83] offset:2048
    v_mfma_f32_16x16x16_bf16 v[132:135], a[202:203], v[226:227], v[132:135]
    buffer_load_dwordx4 v248, s[24:27], s39 offen  lds
    v_add_u32 v248, 0x8000, v248
    v_mfma_f32_16x16x16_bf16 v[136:139], a[212:213], v[226:227], v[136:139]
    v_and_b32 v248, 0x7ffff, v248
    v_mul_f32 v144, v144, v242
    v_mfma_f32_16x16x16_bf16 v[140:143], a[222:223], v[226:227], v[140:143]
    v_mul_f32 v145, v145, v242
    v_mul_f32 v146, v146, v242
    buffer_load_dwordx2 v[238:239], off, s[52:55], s98 sc1
    v_mul_f32 v147, v147, v242
    v_pk_mul_f32 v[148:149], v[148:149], v[242:243] op_sel_hi:[1,0]
    v_pk_mul_f32 v[150:151], v[150:151], v[242:243] op_sel_hi:[1,0]
    v_cvt_pk_bf16_f32 v228, v144, v145
    v_cvt_pk_bf16_f32 v229, v146, v147
    v_cvt_pk_bf16_f32 v230, v148, v149
    v_cvt_pk_bf16_f32 v231, v150, v151
    v_cvt_pk_bf16_f32 v84, v40, v41
    v_cvt_pk_bf16_f32 v85, v42, v43
    v_mfma_f32_16x16x32_bf16 v[144:147], a[64:67], v[228:231], 0
    v_cvt_pk_bf16_f32 v86, v44, v45
    v_cvt_pk_bf16_f32 v87, v46, v47
    v_mfma_f32_16x16x32_bf16 v[148:151], a[74:77], v[228:231], 0
    ds_write_b128 v1, v[84:87] offset:2048
    v_mfma_f32_16x16x32_bf16 v[164:167], a[194:197], v[228:231], 0
    v_mul_f32 v152, v152, v242
    v_mul_f32 v153, v153, v242
    v_mfma_f32_16x16x32_bf16 v[168:171], a[204:207], v[228:231], 0
    v_mul_f32 v154, v154, v242
    v_mul_f32 v155, v155, v242
    v_mfma_f32_16x16x32_bf16 v[172:175], a[214:217], v[228:231], 0
    v_mul_f32 v156, v156, v242
    v_mul_f32 v157, v157, v242
    v_mul_f32 v158, v158, v242
    v_mul_f32 v159, v159, v242
    v_cvt_pk_bf16_f32 v232, v152, v153
    v_cvt_pk_bf16_f32 v233, v154, v155
    v_mfma_f32_16x16x32_bf16 v[152:155], a[84:87], v[228:231], 0
    v_cvt_pk_bf16_f32 v234, v156, v157
    v_cvt_pk_bf16_f32 v235, v158, v159
    v_mfma_f32_16x16x32_bf16 v[156:159], a[94:97], v[228:231], 0
    v_cvt_pk_bf16_f32 v80, v112, v113
    v_cvt_pk_bf16_f32 v81, v114, v115
    v_mfma_f32_16x16x32_bf16 v[144:147], a[68:71], v[232:235], v[144:147]
    v_cvt_pk_bf16_f32 v82, v116, v117
    v_cvt_pk_bf16_f32 v83, v118, v119
    v_mfma_f32_16x16x32_bf16 v[148:151], a[78:81], v[232:235], v[148:151]
    ds_write_b128 v249, v[80:83] offset:3072
    v_mfma_f32_16x16x32_bf16 v[152:155], a[88:91], v[232:235], v[152:155]
    v_mul_f32 v160, v160, v242
    v_mul_f32 v161, v161, v242
    v_mfma_f32_16x16x32_bf16 v[156:159], a[98:101], v[232:235], v[156:159]
    v_mul_f32 v162, v162, v242
    v_mul_f32 v163, v163, v242
    v_mfma_f32_16x16x32_bf16 v[164:167], a[198:201], v[232:235], v[164:167]
    v_cvt_pk_bf16_f32 v236, v160, v161
    v_cvt_pk_bf16_f32 v237, v162, v163
    v_mfma_f32_16x16x32_bf16 v[160:163], a[184:187], v[228:231], 0
    v_cvt_pk_bf16_f32 v84, v120, v121
    v_cvt_pk_bf16_f32 v85, v122, v123
    v_mfma_f32_16x16x16_bf16 v[144:147], a[72:73], v[236:237], v[144:147]
    v_cvt_pk_bf16_f32 v86, v124, v125
    v_cvt_pk_bf16_f32 v87, v126, v127
    v_mfma_f32_16x16x16_bf16 v[148:151], a[82:83], v[236:237], v[148:151]
    ds_write_b128 v6, v[84:87] offset:3072
    v_mfma_f32_16x16x16_bf16 v[152:155], a[92:93], v[236:237], v[152:155]
    v_cvt_pk_bf16_f32 v80, v128, v129
    v_cvt_pk_bf16_f32 v81, v130, v131
    v_mfma_f32_16x16x16_bf16 v[156:159], a[102:103], v[236:237], v[156:159]
    v_cvt_pk_bf16_f32 v82, v132, v133
    v_cvt_pk_bf16_f32 v83, v134, v135
    v_mfma_f32_16x16x32_bf16 v[160:163], a[188:191], v[232:235], v[160:163]
    ds_write_b128 v7, v[80:83] offset:3072
    v_mfma_f32_16x16x16_bf16 v[164:167], a[202:203], v[236:237], v[164:167]
    v_cvt_pk_bf16_f32 v84, v136, v137
    v_cvt_pk_bf16_f32 v85, v138, v139
    v_mfma_f32_16x16x32_bf16 v[168:171], a[208:211], v[232:235], v[168:171]
    v_cvt_pk_bf16_f32 v86, v140, v141
    v_cvt_pk_bf16_f32 v87, v142, v143
    v_mfma_f32_16x16x16_bf16 v[160:163], a[192:193], v[236:237], v[160:163]
    ds_write_b128 v1, v[84:87] offset:3072
    v_mfma_f32_16x16x32_bf16 v[172:175], a[218:221], v[232:235], v[172:175]
    v_cvt_pk_bf16_f32 v80, v144, v145
    v_cvt_pk_bf16_f32 v81, v146, v147
    v_mfma_f32_16x16x16_bf16 v[168:171], a[212:213], v[236:237], v[168:171]
    v_cvt_pk_bf16_f32 v82, v148, v149
    v_cvt_pk_bf16_f32 v83, v150, v151
    v_cvt_pk_bf16_f32 v84, v152, v153
    v_mfma_f32_16x16x16_bf16 v[172:175], a[222:223], v[236:237], v[172:175]
    ds_write_b128 v249, v[80:83] offset:4096
    v_cvt_pk_bf16_f32 v85, v154, v155
    v_cvt_pk_bf16_f32 v86, v156, v157
    v_cvt_pk_bf16_f32 v87, v158, v159
    v_cvt_pk_bf16_f32 v80, v160, v161
    v_cvt_pk_bf16_f32 v81, v162, v163
    v_cvt_pk_bf16_f32 v82, v164, v165
    v_cvt_pk_bf16_f32 v83, v166, v167
    ds_write_b128 v6, v[84:87] offset:4096
    ds_write_b128 v7, v[80:83] offset:4096
    s_nop 0
    v_cvt_pk_bf16_f32 v84, v168, v169
    v_cvt_pk_bf16_f32 v85, v170, v171
    v_cvt_pk_bf16_f32 v86, v172, v173
    v_cvt_pk_bf16_f32 v87, v174, v175
    ds_write_b128 v1, v[84:87] offset:4096
    s_waitcnt lgkmcnt(0)
    s_barrier
    ds_read_b128 a[104:107], v2 offset:0
    ds_read_b128 a[108:111], v2 offset:1024
    ds_read_b128 a[112:115], v2 offset:2048
    ds_read_b128 a[116:119], v2 offset:3072
    ds_read_b128 a[120:123], v2 offset:4096
    s_waitcnt lgkmcnt(0)
    v_mfma_f32_16x16x32_bf16 v[16:19], v[176:179], a[104:107], 0
    s_add_u32 m0, s4, 8192
    s_waitcnt vmcnt(13)
    ds_read_b64_tr_b16 v[192:193], v252 offset:12288
    v_mfma_f32_16x16x32_bf16 v[32:35], v[176:179], a[108:111], 0
    ds_read_b64_tr_b16 v[194:195], v252 offset:14336
    ds_read_b128 a[124:127], v2 offset:5120
    v_mfma_f32_16x16x32_bf16 v[48:51], v[176:179], a[112:115], 0
    ds_read_b128 a[128:131], v2 offset:6144
    buffer_load_dwordx4 v248, s[24:27], 0 offen  lds
    v_mfma_f32_16x16x32_bf16 v[64:67], v[176:179], a[116:119], 0
    s_lshl_b32 s5, s47, 1
    s_sub_u32 s58, s49, s5
    v_mfma_f32_16x16x32_bf16 v[80:83], v[176:179], a[120:123], 0
    s_cmp_eq_u32 s58, 0
    s_cselect_b32 s59, 0x10000000, 0
    s_cmp_eq_u32 s58, 1
    s_cselect_b32 s6, 0x10000000, 0
    v_mfma_f32_16x16x32_bf16 v[84:87], v[180:183], a[120:123], 0
    s_add_u32 m0, s4, 9216
    ds_read_b64_tr_b16 v[196:197], v253 offset:12288
    v_mfma_f32_16x16x32_bf16 v[68:71], v[180:183], a[116:119], 0
    ds_read_b64_tr_b16 v[198:199], v253 offset:14336
    ds_read_b128 a[132:135], v2 offset:7168
    v_mfma_f32_16x16x32_bf16 v[52:55], v[180:183], a[112:115], 0
    ds_read_b128 a[136:139], v2 offset:8192
    buffer_load_dwordx4 v248, s[24:27], s37 offen  lds
    v_mfma_f32_16x16x32_bf16 v[36:39], v[180:183], a[108:111], 0
    s_add_u32 s57, s6, 81920
    s_mul_i32 s5, s47, 163840
    v_mfma_f32_16x16x32_bf16 v[20:23], v[180:183], a[104:107], 0
    s_mul_i32 s6, s49, 5120
    s_add_u32 s5, s5, s6
    v_mfma_f32_16x16x32_bf16 v[24:27], v[184:187], a[104:107], 0
    s_add_u32 m0, s4, 10240
    ds_read_b64_tr_b16 v[200:201], v254 offset:12288
    v_mfma_f32_16x16x32_bf16 v[40:43], v[184:187], a[108:111], 0
    ds_read_b64_tr_b16 v[202:203], v254 offset:14336
    ds_read_b128 a[140:143], v2 offset:9216
    v_mfma_f32_16x16x32_bf16 v[56:59], v[184:187], a[112:115], 0
    buffer_load_dwordx4 v248, s[24:27], s38 offen  lds
    s_lshl_b32 s3, s49, 2
    v_mfma_f32_16x16x32_bf16 v[72:75], v[184:187], a[116:119], 0
    s_lshl_b32 s6, s47, 9
    s_add_u32 s3, s3, s6
    v_mfma_f32_16x16x32_bf16 v[88:91], v[184:187], a[120:123], 0
    v_lshl_add_u32 v5, v0, 4, s5
    v_mov_b32 v235, 0x3f80
    v_mfma_f32_16x16x32_bf16 v[92:95], v[188:191], a[120:123], 0
    s_add_u32 m0, s4, 11264
    ds_read_b64_tr_b16 v[204:205], v255 offset:12288
    v_mfma_f32_16x16x32_bf16 v[76:79], v[188:191], a[116:119], 0
    ds_read_b64_tr_b16 v[206:207], v255 offset:14336
    buffer_load_dwordx4 v248, s[24:27], s39 offen  lds
    v_mfma_f32_16x16x32_bf16 v[60:63], v[188:191], a[112:115], 0
    v_add_u32 v248, 0x8000, v248
    v_and_b32 v248, 0x7ffff, v248
    v_mfma_f32_16x16x32_bf16 v[44:47], v[188:191], a[108:111], 0
    v_lshl_add_u32 v216, v0, 8, s3
    v_mov_b32 v217, 1
    v_mfma_f32_16x16x32_bf16 v[28:31], v[188:191], a[104:107], 0
    s_lshl_b32 s3, s49, 8
    v_and_b32 v3, 7, v0
    s_waitcnt lgkmcnt(2)
    v_mfma_f32_16x16x32_bf16 v[16:19], v[192:195], a[124:127], v[16:19]
    s_add_u32 m0, s4, 12288
    s_waitcnt vmcnt(13)
    ds_read_b64_tr_b16 v[176:177], v252 offset:16384
    v_mfma_f32_16x16x32_bf16 v[32:35], v[192:195], a[128:131], v[32:35]
    ds_read_b64_tr_b16 v[178:179], v252 offset:18432
    ds_read_b128 a[104:107], v2 offset:10240
    v_mfma_f32_16x16x32_bf16 v[48:51], v[192:195], a[132:135], v[48:51]
    ds_read_b128 a[108:111], v2 offset:11264
    s_waitcnt lgkmcnt(4)
    buffer_load_dwordx4 v248, s[24:27], 0 offen  lds
    v_mfma_f32_16x16x32_bf16 v[64:67], v[192:195], a[136:139], v[64:67]
    s_lshl_b32 s6, s47, 8
    v_lshl_add_u32 v218, v3, 2, s3
    v_mfma_f32_16x16x32_bf16 v[80:83], v[192:195], a[140:143], v[80:83]
    s_mul_i32 s3, s49, 81920
    s_add_u32 s3, s3, s6
    v_mfma_f32_16x16x32_bf16 v[84:87], v[196:199], a[140:143], v[84:87]
    s_add_u32 m0, s4, 13312
    ds_read_b64_tr_b16 v[180:181], v253 offset:16384
    v_mfma_f32_16x16x32_bf16 v[68:71], v[196:199], a[136:139], v[68:71]
    ds_read_b64_tr_b16 v[182:183], v253 offset:18432
    ds_read_b128 a[112:115], v2 offset:12288
    v_mfma_f32_16x16x32_bf16 v[52:55], v[196:199], a[132:135], v[52:55]
    ds_read_b128 a[116:119], v2 offset:13312
    buffer_load_dwordx4 v248, s[24:27], s37 offen  lds
    v_mfma_f32_16x16x32_bf16 v[36:39], v[196:199], a[128:131], v[36:39]
    v_lshrrev_b32 v3, 4, v0
    v_mul_u32_u24 v3, 5120, v3
    v_mfma_f32_16x16x32_bf16 v[20:23], v[196:199], a[124:127], v[20:23]
    v_and_b32 v4, 15, v0
    v_lshl_add_u32 v3, v4, 4, v3
    v_mfma_f32_16x16x32_bf16 v[24:27], v[200:203], a[124:127], v[24:27]
    s_add_u32 m0, s4, 14336
    ds_read_b64_tr_b16 v[184:185], v254 offset:16384
    v_mfma_f32_16x16x32_bf16 v[40:43], v[200:203], a[128:131], v[40:43]
    ds_read_b64_tr_b16 v[186:187], v254 offset:18432
    ds_read_b128 a[120:123], v2 offset:14336
    v_mfma_f32_16x16x32_bf16 v[56:59], v[200:203], a[132:135], v[56:59]
    buffer_load_dwordx4 v248, s[24:27], s38 offen  lds
    v_add_u32 v219, s3, v3
    v_mfma_f32_16x16x32_bf16 v[72:75], v[200:203], a[136:139], v[72:75]
    s_lshl_b32 s3, s47, 3
    v_mul_u32_u24 v6, 144, v4
    v_mfma_f32_16x16x32_bf16 v[88:91], v[200:203], a[140:143], v[88:91]
    v_lshrrev_b32 v3, 4, v0
    v_lshl_add_u32 v6, v3, 5, v6
    v_mfma_f32_16x16x32_bf16 v[92:95], v[204:207], a[140:143], v[92:95]
    s_add_u32 m0, s4, 15360
    ds_read_b64_tr_b16 v[188:189], v255 offset:16384
    v_mfma_f32_16x16x32_bf16 v[76:79], v[204:207], a[136:139], v[76:79]
    ds_read_b64_tr_b16 v[190:191], v255 offset:18432
    buffer_load_dwordx4 v248, s[24:27], s39 offen  lds
    v_mfma_f32_16x16x32_bf16 v[60:63], v[204:207], a[132:135], v[60:63]
    v_add_u32 v248, 0x8000, v248
    v_and_b32 v248, 0x7ffff, v248
    v_mfma_f32_16x16x32_bf16 v[44:47], v[204:207], a[128:131], v[44:47]
    v_add_u32 v6, s3, v6
    v_and_b32 v3, 1, v0
    v_mfma_f32_16x16x32_bf16 v[28:31], v[204:207], a[124:127], v[28:31]
    v_lshlrev_b32 v3, 4, v3
    v_lshlrev_b32 v3, v3, v235
    s_waitcnt lgkmcnt(2)
    v_mfma_f32_16x16x32_bf16 v[16:19], v[176:179], a[104:107], v[16:19]
    s_add_u32 m0, s4, 16384
    s_waitcnt vmcnt(13)
    ds_read_b64_tr_b16 v[192:193], v252 offset:0
    v_mfma_f32_16x16x32_bf16 v[32:35], v[176:179], a[108:111], v[32:35]
    ds_read_b64_tr_b16 v[194:195], v252 offset:2048
    ds_read_b128 a[124:127], v2 offset:15360
    v_mfma_f32_16x16x32_bf16 v[48:51], v[176:179], a[112:115], v[48:51]
    ds_read_b128 a[128:131], v2 offset:16384
    s_waitcnt lgkmcnt(4)
    buffer_load_dwordx4 v248, s[24:27], 0 offen  lds
    v_mfma_f32_16x16x32_bf16 v[64:67], v[176:179], a[116:119], v[64:67]
    v_bfe_u32 v7, v0, 1, 3
    v_cmp_eq_u32 vcc, 0, v7
    v_mfma_f32_16x16x32_bf16 v[80:83], v[176:179], a[120:123], v[80:83]
    v_cmp_eq_u32 s[6:7], 1, v7
    v_cndmask_b32 v228, 0, v3, vcc
    v_mfma_f32_16x16x32_bf16 v[84:87], v[180:183], a[120:123], v[84:87]
    s_add_u32 m0, s4, 17408
    ds_read_b64_tr_b16 v[196:197], v253 offset:0
    v_mfma_f32_16x16x32_bf16 v[68:71], v[180:183], a[116:119], v[68:71]
    ds_read_b64_tr_b16 v[198:199], v253 offset:2048
    ds_read_b128 a[132:135], v2 offset:17408
    v_mfma_f32_16x16x32_bf16 v[52:55], v[180:183], a[112:115], v[52:55]
    ds_read_b128 a[136:139], v2 offset:18432
    buffer_load_dwordx4 v248, s[24:27], s37 offen  lds
    v_mfma_f32_16x16x32_bf16 v[36:39], v[180:183], a[108:111], v[36:39]
    v_cndmask_b32 v229, 0, v3, s[6:7]
    v_cmp_eq_u32 vcc, 2, v7
    v_mfma_f32_16x16x32_bf16 v[20:23], v[180:183], a[104:107], v[20:23]
    v_cmp_eq_u32 s[6:7], 3, v7
    v_cndmask_b32 v230, 0, v3, vcc
    v_mfma_f32_16x16x32_bf16 v[24:27], v[184:187], a[104:107], v[24:27]
    s_add_u32 m0, s4, 18432
    ds_read_b64_tr_b16 v[200:201], v254 offset:0
    v_mfma_f32_16x16x32_bf16 v[40:43], v[184:187], a[108:111], v[40:43]
    ds_read_b64_tr_b16 v[202:203], v254 offset:2048
    ds_read_b128 a[140:143], v2 offset:19456
    v_mfma_f32_16x16x32_bf16 v[56:59], v[184:187], a[112:115], v[56:59]
    buffer_load_dwordx4 v248, s[24:27], s38 offen  lds
    v_cndmask_b32 v231, 0, v3, s[6:7]
    v_mfma_f32_16x16x32_bf16 v[72:75], v[184:187], a[116:119], v[72:75]
    v_cmp_eq_u32 vcc, 4, v7
    v_cmp_eq_u32 s[6:7], 5, v7
    v_mfma_f32_16x16x32_bf16 v[88:91], v[184:187], a[120:123], v[88:91]
    v_cndmask_b32 v232, 0, v3, vcc
    v_cndmask_b32 v233, 0, v3, s[6:7]
    v_mfma_f32_16x16x32_bf16 v[92:95], v[188:191], a[120:123], v[92:95]
    s_add_u32 m0, s4, 19456
    ds_read_b64_tr_b16 v[204:205], v255 offset:0
    v_mfma_f32_16x16x32_bf16 v[76:79], v[188:191], a[116:119], v[76:79]
    ds_read_b64_tr_b16 v[206:207], v255 offset:2048
    buffer_load_dwordx4 v248, s[24:27], s39 offen  lds
    v_mfma_f32_16x16x32_bf16 v[60:63], v[188:191], a[112:115], v[60:63]
    v_add_u32 v248, 0x8000, v248
    v_and_b32 v248, 0x7ffff, v248
    v_mfma_f32_16x16x32_bf16 v[44:47], v[188:191], a[108:111], v[44:47]
    v_cmp_eq_u32 vcc, 6, v7
    v_cmp_eq_u32 s[6:7], 7, v7
    v_mfma_f32_16x16x32_bf16 v[28:31], v[188:191], a[104:107], v[28:31]
    v_cndmask_b32 v234, 0, v3, vcc
    v_cndmask_b32 v235, 0, v3, s[6:7]
    s_waitcnt lgkmcnt(2)
    v_mfma_f32_16x16x32_bf16 v[16:19], v[192:195], a[124:127], v[16:19]
    s_add_u32 m0, s4, 0
    s_waitcnt vmcnt(13)
    ds_read_b64_tr_b16 v[176:177], v252 offset:4096
    v_mfma_f32_16x16x32_bf16 v[32:35], v[192:195], a[128:131], v[32:35]
    ds_read_b64_tr_b16 v[178:179], v252 offset:6144
    ds_read_b128 a[104:107], v2 offset:20480
    v_mfma_f32_16x16x32_bf16 v[48:51], v[192:195], a[132:135], v[48:51]
    ds_read_b128 a[108:111], v2 offset:21504
    s_waitcnt lgkmcnt(4)
    buffer_load_dwordx4 v248, s[24:27], 0 offen  lds
    v_mfma_f32_16x16x32_bf16 v[64:67], v[192:195], a[136:139], v[64:67]
    s_mul_i32 s3, s47, 20
    v_lshrrev_b32 v3, 3, v0
    v_mfma_f32_16x16x32_bf16 v[80:83], v[192:195], a[140:143], v[80:83]
    v_add_u32 v3, s3, v3
    v_mul_u32_u24 v7, 144, v3
    v_mfma_f32_16x16x32_bf16 v[84:87], v[196:199], a[140:143], v[84:87]
    s_add_u32 m0, s4, 1024
    ds_read_b64_tr_b16 v[180:181], v253 offset:4096
    v_mfma_f32_16x16x32_bf16 v[68:71], v[196:199], a[136:139], v[68:71]
    ds_read_b64_tr_b16 v[182:183], v253 offset:6144
    ds_read_b128 a[112:115], v2 offset:22528
    v_mfma_f32_16x16x32_bf16 v[52:55], v[196:199], a[132:135], v[52:55]
    ds_read_b128 a[116:119], v2 offset:23552
    buffer_load_dwordx4 v248, s[24:27], s37 offen  lds
    v_mfma_f32_16x16x32_bf16 v[36:39], v[196:199], a[128:131], v[36:39]
    v_and_b32 v4, 7, v0
    v_lshl_add_u32 v7, v4, 4, v7
    v_mfma_f32_16x16x32_bf16 v[20:23], v[196:199], a[124:127], v[20:23]
    v_lshlrev_b32 v3, 11, v3
    v_and_b32 v4, 3, v0
    v_mfma_f32_16x16x32_bf16 v[24:27], v[200:203], a[124:127], v[24:27]
    s_add_u32 m0, s4, 2048
    ds_read_b64_tr_b16 v[184:185], v254 offset:4096
    v_mfma_f32_16x16x32_bf16 v[40:43], v[200:203], a[128:131], v[40:43]
    ds_read_b64_tr_b16 v[186:187], v254 offset:6144
    ds_read_b128 a[120:123], v2 offset:24576
    v_mfma_f32_16x16x32_bf16 v[56:59], v[200:203], a[132:135], v[56:59]
    buffer_load_dwordx4 v248, s[24:27], s38 offen  lds
    s_lshr_b32 s3, s48, 3
    v_mfma_f32_16x16x32_bf16 v[72:75], v[200:203], a[136:139], v[72:75]
    v_lshl_add_u32 v3, v4, 4, v3
    v_bfe_u32 v4, v0, 2, 1
    v_mfma_f32_16x16x32_bf16 v[88:91], v[200:203], a[140:143], v[88:91]
    v_xor_b32 v4, s3, v4
    v_lshl_add_u32 v3, v4, 7, v3
    v_mfma_f32_16x16x32_bf16 v[92:95], v[204:207], a[140:143], v[92:95]
    s_add_u32 m0, s4, 3072
    ds_read_b64_tr_b16 v[188:189], v255 offset:4096
    v_mfma_f32_16x16x32_bf16 v[76:79], v[204:207], a[136:139], v[76:79]
    ds_read_b64_tr_b16 v[190:191], v255 offset:6144
    buffer_load_dwordx4 v248, s[24:27], s39 offen  lds
    v_mfma_f32_16x16x32_bf16 v[60:63], v[204:207], a[132:135], v[60:63]
    s_mul_i32 s3, s48, 163840
    s_lshl_b32 s6, s50, 10
    v_mfma_f32_16x16x32_bf16 v[44:47], v[204:207], a[128:131], v[44:47]
    s_add_u32 s3, s3, s6
    s_lshr_b32 s6, s49, 1
    v_mfma_f32_16x16x32_bf16 v[28:31], v[204:207], a[124:127], v[28:31]
    v_add_u32 v248, 0x8000, v248
    v_and_b32 v248, 0x7ffff, v248
    s_waitcnt lgkmcnt(2)
    v_mfma_f32_16x16x32_bf16 v[16:19], v[176:179], a[104:107], v[16:19]
    s_add_u32 m0, s4, 4096
    s_waitcnt vmcnt(12)
    ds_read_b64_tr_b16 v[192:193], v252 offset:8192
    v_mfma_f32_16x16x32_bf16 v[32:35], v[176:179], a[108:111], v[32:35]
    ds_read_b64_tr_b16 v[194:195], v252 offset:10240
    ds_read_b128 a[124:127], v2 offset:25600
    v_mfma_f32_16x16x32_bf16 v[48:51], v[176:179], a[112:115], v[48:51]
    ds_read_b128 a[128:131], v2 offset:26624
    s_waitcnt lgkmcnt(4)
    buffer_load_dwordx4 v248, s[24:27], 0 offen  lds
    v_mfma_f32_16x16x32_bf16 v[64:67], v[176:179], a[116:119], v[64:67]
    s_lshl_b32 s6, s6, 8
    s_add_u32 s3, s3, s6
    v_mfma_f32_16x16x32_bf16 v[80:83], v[176:179], a[120:123], v[80:83]
    s_and_b32 s6, s49, 1
    s_lshl_b32 s6, s6, 6
    v_mfma_f32_16x16x32_bf16 v[84:87], v[180:183], a[120:123], v[84:87]
    s_add_u32 m0, s4, 5120
    ds_read_b64_tr_b16 v[196:197], v253 offset:8192
    v_mfma_f32_16x16x32_bf16 v[68:71], v[180:183], a[116:119], v[68:71]
    ds_read_b64_tr_b16 v[198:199], v253 offset:10240
    ds_read_b128 a[132:135], v2 offset:27648
    v_mfma_f32_16x16x32_bf16 v[52:55], v[180:183], a[112:115], v[52:55]
    ds_read_b128 a[136:139], v2 offset:28672
    buffer_load_dwordx4 v248, s[24:27], s37 offen  lds
    v_mfma_f32_16x16x32_bf16 v[36:39], v[180:183], a[108:111], v[36:39]
    s_add_u32 s3, s3, s6
    v_add_u32 v4, s3, v3
    v_mfma_f32_16x16x32_bf16 v[20:23], v[180:183], a[104:107], v[20:23]
    v_mfma_f32_16x16x32_bf16 v[24:27], v[184:187], a[104:107], v[24:27]
    s_add_u32 m0, s4, 6144
    ds_read_b64_tr_b16 v[200:201], v254 offset:8192
    v_mfma_f32_16x16x32_bf16 v[40:43], v[184:187], a[108:111], v[40:43]
    ds_read_b64_tr_b16 v[202:203], v254 offset:10240
    ds_read_b128 a[140:143], v2 offset:29696
    v_mfma_f32_16x16x32_bf16 v[56:59], v[184:187], a[112:115], v[56:59]
    buffer_load_dwordx4 v248, s[24:27], s38 offen  lds
    v_mfma_f32_16x16x32_bf16 v[72:75], v[184:187], a[116:119], v[72:75]
    v_mfma_f32_16x16x32_bf16 v[88:91], v[184:187], a[120:123], v[88:91]
    v_mfma_f32_16x16x32_bf16 v[92:95], v[188:191], a[120:123], v[92:95]
    s_add_u32 m0, s4, 7168
    ds_read_b64_tr_b16 v[204:205], v255 offset:8192
    v_mfma_f32_16x16x32_bf16 v[76:79], v[188:191], a[116:119], v[76:79]
    ds_read_b64_tr_b16 v[206:207], v255 offset:10240
    buffer_load_dwordx4 v248, s[24:27], s39 offen  lds
    v_mfma_f32_16x16x32_bf16 v[60:63], v[188:191], a[112:115], v[60:63]
    v_add_u32 v248, 0x8000, v248
    v_and_b32 v248, 0x7ffff, v248
    v_mfma_f32_16x16x32_bf16 v[44:47], v[188:191], a[108:111], v[44:47]
    v_mfma_f32_16x16x32_bf16 v[28:31], v[188:191], a[104:107], v[28:31]
    s_waitcnt lgkmcnt(2)
    v_mfma_f32_16x16x32_bf16 v[16:19], v[192:195], a[124:127], v[16:19]
    s_add_u32 m0, s4, 8192
    s_waitcnt vmcnt(12)
    ds_read_b64_tr_b16 v[176:177], v252 offset:12288
    v_mfma_f32_16x16x32_bf16 v[32:35], v[192:195], a[128:131], v[32:35]
    ds_read_b64_tr_b16 v[178:179], v252 offset:14336
    ds_read_b128 a[104:107], v2 offset:30720
    v_mfma_f32_16x16x32_bf16 v[48:51], v[192:195], a[132:135], v[48:51]
    ds_read_b128 a[108:111], v2 offset:31744
    s_waitcnt lgkmcnt(4)
    buffer_load_dwordx4 v248, s[24:27], 0 offen  lds
    v_mfma_f32_16x16x32_bf16 v[64:67], v[192:195], a[136:139], v[64:67]
    v_mfma_f32_16x16x32_bf16 v[80:83], v[192:195], a[140:143], v[80:83]
    v_mfma_f32_16x16x32_bf16 v[84:87], v[196:199], a[140:143], v[84:87]
    s_add_u32 m0, s4, 9216
    ds_read_b64_tr_b16 v[180:181], v253 offset:12288
    v_mfma_f32_16x16x32_bf16 v[68:71], v[196:199], a[136:139], v[68:71]
    ds_read_b64_tr_b16 v[182:183], v253 offset:14336
    ds_read_b128 a[112:115], v2 offset:32768
    v_mfma_f32_16x16x32_bf16 v[52:55], v[196:199], a[132:135], v[52:55]
    ds_read_b128 a[116:119], v2 offset:33792
    buffer_load_dwordx4 v248, s[24:27], s37 offen  lds
    v_mfma_f32_16x16x32_bf16 v[36:39], v[196:199], a[128:131], v[36:39]
    v_mfma_f32_16x16x32_bf16 v[20:23], v[196:199], a[124:127], v[20:23]
    v_mfma_f32_16x16x32_bf16 v[24:27], v[200:203], a[124:127], v[24:27]
    s_add_u32 m0, s4, 10240
    ds_read_b64_tr_b16 v[184:185], v254 offset:12288
    v_mfma_f32_16x16x32_bf16 v[40:43], v[200:203], a[128:131], v[40:43]
    ds_read_b64_tr_b16 v[186:187], v254 offset:14336
    ds_read_b128 a[120:123], v2 offset:34816
    v_mfma_f32_16x16x32_bf16 v[56:59], v[200:203], a[132:135], v[56:59]
    buffer_load_dwordx4 v248, s[24:27], s38 offen  lds
    v_mfma_f32_16x16x32_bf16 v[72:75], v[200:203], a[136:139], v[72:75]
    v_mfma_f32_16x16x32_bf16 v[88:91], v[200:203], a[140:143], v[88:91]
    v_mfma_f32_16x16x32_bf16 v[92:95], v[204:207], a[140:143], v[92:95]
    s_add_u32 m0, s4, 11264
    ds_read_b64_tr_b16 v[188:189], v255 offset:12288
    v_mfma_f32_16x16x32_bf16 v[76:79], v[204:207], a[136:139], v[76:79]
    ds_read_b64_tr_b16 v[190:191], v255 offset:14336
    buffer_load_dwordx4 v248, s[24:27], s39 offen  lds
    v_mfma_f32_16x16x32_bf16 v[60:63], v[204:207], a[132:135], v[60:63]
    v_add_u32 v248, 0x8000, v248
    v_and_b32 v248, 0x7ffff, v248
    v_mfma_f32_16x16x32_bf16 v[44:47], v[204:207], a[128:131], v[44:47]
    v_mfma_f32_16x16x32_bf16 v[28:31], v[204:207], a[124:127], v[28:31]
    s_waitcnt lgkmcnt(2)
    v_mfma_f32_16x16x32_bf16 v[16:19], v[176:179], a[104:107], v[16:19]
    s_add_u32 m0, s4, 12288
    s_waitcnt vmcnt(12)
    ds_read_b64_tr_b16 v[192:193], v252 offset:16384
    v_mfma_f32_16x16x32_bf16 v[32:35], v[176:179], a[108:111], v[32:35]
    ds_read_b64_tr_b16 v[194:195], v252 offset:18432
    ds_read_b128 a[124:127], v2 offset:35840
    v_mfma_f32_16x16x32_bf16 v[48:51], v[176:179], a[112:115], v[48:51]
    ds_read_b128 a[128:131], v2 offset:36864
    s_waitcnt lgkmcnt(4)
    buffer_load_dwordx4 v248, s[24:27], 0 offen  lds
    v_mfma_f32_16x16x32_bf16 v[64:67], v[176:179], a[116:119], v[64:67]
    v_mfma_f32_16x16x32_bf16 v[80:83], v[176:179], a[120:123], v[80:83]
    v_mfma_f32_16x16x32_bf16 v[84:87], v[180:183], a[120:123], v[84:87]
    s_add_u32 m0, s4, 13312
    ds_read_b64_tr_b16 v[196:197], v253 offset:16384
    v_mfma_f32_16x16x32_bf16 v[68:71], v[180:183], a[116:119], v[68:71]
    ds_read_b64_tr_b16 v[198:199], v253 offset:18432
    ds_read_b128 a[132:135], v2 offset:37888
    v_mfma_f32_16x16x32_bf16 v[52:55], v[180:183], a[112:115], v[52:55]
    ds_read_b128 a[136:139], v2 offset:38912
    buffer_load_dwordx4 v248, s[24:27], s37 offen  lds
    v_mfma_f32_16x16x32_bf16 v[36:39], v[180:183], a[108:111], v[36:39]
    v_mfma_f32_16x16x32_bf16 v[20:23], v[180:183], a[104:107], v[20:23]
    v_mfma_f32_16x16x32_bf16 v[24:27], v[184:187], a[104:107], v[24:27]
    s_add_u32 m0, s4, 14336
    ds_read_b64_tr_b16 v[200:201], v254 offset:16384
    v_mfma_f32_16x16x32_bf16 v[40:43], v[184:187], a[108:111], v[40:43]
    ds_read_b64_tr_b16 v[202:203], v254 offset:18432
    ds_read_b128 a[140:143], v2 offset:39936
    v_mfma_f32_16x16x32_bf16 v[56:59], v[184:187], a[112:115], v[56:59]
    buffer_load_dwordx4 v248, s[24:27], s38 offen  lds
    v_mfma_f32_16x16x32_bf16 v[72:75], v[184:187], a[116:119], v[72:75]
    v_mfma_f32_16x16x32_bf16 v[88:91], v[184:187], a[120:123], v[88:91]
    v_mfma_f32_16x16x32_bf16 v[92:95], v[188:191], a[120:123], v[92:95]
    s_add_u32 m0, s4, 15360
    ds_read_b64_tr_b16 v[204:205], v255 offset:16384
    v_mfma_f32_16x16x32_bf16 v[76:79], v[188:191], a[116:119], v[76:79]
    ds_read_b64_tr_b16 v[206:207], v255 offset:18432
    buffer_load_dwordx4 v248, s[24:27], s39 offen  lds
    v_mfma_f32_16x16x32_bf16 v[60:63], v[188:191], a[112:115], v[60:63]
    v_add_u32 v248, 0x8000, v248
    v_and_b32 v248, 0x7ffff, v248
    v_mfma_f32_16x16x32_bf16 v[44:47], v[188:191], a[108:111], v[44:47]
    v_mfma_f32_16x16x32_bf16 v[28:31], v[188:191], a[104:107], v[28:31]
    s_waitcnt lgkmcnt(2)
    v_mfma_f32_16x16x32_bf16 v[16:19], v[192:195], a[124:127], v[16:19]
    s_add_u32 m0, s4, 16384
    s_waitcnt vmcnt(12)
    ds_read_b64_tr_b16 v[176:177], v252 offset:0
    v_mfma_f32_16x16x32_bf16 v[32:35], v[192:195], a[128:131], v[32:35]
    ds_read_b64_tr_b16 v[178:179], v252 offset:2048
    s_waitcnt lgkmcnt(2)
    buffer_load_dwordx4 v248, s[24:27], 0 offen  lds
    v_mfma_f32_16x16x32_bf16 v[48:51], v[192:195], a[132:135], v[48:51]
    v_add_u32 v2, 40960, v2
    v_and_b32 v223, v238, v239
    v_mfma_f32_16x16x32_bf16 v[64:67], v[192:195], a[136:139], v[64:67]
    ds_read_b128 a[104:107], v2 offset:0
    ds_read_b128 a[108:111], v2 offset:1024
    v_mfma_f32_16x16x32_bf16 v[80:83], v[192:195], a[140:143], v[80:83]
    v_mfma_f32_16x16x32_bf16 v[84:87], v[196:199], a[140:143], v[84:87]
    s_add_u32 m0, s4, 17408
    ds_read_b64_tr_b16 v[180:181], v253 offset:0
    v_mfma_f32_16x16x32_bf16 v[68:71], v[196:199], a[136:139], v[68:71]
    ds_read_b64_tr_b16 v[182:183], v253 offset:2048
    ds_read_b128 a[112:115], v2 offset:2048
    v_mfma_f32_16x16x32_bf16 v[52:55], v[196:199], a[132:135], v[52:55]
    ds_read_b128 a[116:119], v2 offset:3072
    buffer_load_dwordx4 v248, s[24:27], s37 offen  lds
    v_mfma_f32_16x16x32_bf16 v[36:39], v[196:199], a[128:131], v[36:39]
    v_readfirstlane_b32 s99, v223
    v_mfma_f32_16x16x32_bf16 v[20:23], v[196:199], a[124:127], v[20:23]
    v_mfma_f32_16x16x32_bf16 v[24:27], v[200:203], a[124:127], v[24:27]
    s_add_u32 m0, s4, 18432
    ds_read_b64_tr_b16 v[184:185], v254 offset:0
    v_mfma_f32_16x16x32_bf16 v[40:43], v[200:203], a[128:131], v[40:43]
    ds_read_b64_tr_b16 v[186:187], v254 offset:2048
    ds_read_b128 a[120:123], v2 offset:4096
    v_mfma_f32_16x16x32_bf16 v[56:59], v[200:203], a[132:135], v[56:59]
    buffer_load_dwordx4 v248, s[24:27], s38 offen  lds
    s_cmp_eq_u32 s99, 0x01010101
    s_cbranch_scc1 L_clr_ok
    s_mov_b32 s95, 0
L_clr_slow:
    s_add_u32 s95, s95, 1
    s_cmp_gt_u32 s95, 0x40000
    s_cbranch_scc1 L_clr_ok
    buffer_load_dwordx2 v[238:239], off, s[52:55], s98 sc1
    s_waitcnt vmcnt(0)
    v_and_b32 v223, v238, v239
    s_nop 0
    v_readfirstlane_b32 s99, v223
    s_nop 3
    s_cmp_eq_u32 s99, 0x01010101
    s_cbranch_scc0 L_clr_slow
L_clr_ok:
    v_mfma_f32_16x16x32_bf16 v[72:75], v[200:203], a[136:139], v[72:75]
    v_mfma_f32_16x16x32_bf16 v[88:91], v[200:203], a[140:143], v[88:91]
    v_mfma_f32_16x16x32_bf16 v[92:95], v[204:207], a[140:143], v[92:95]
    s_add_u32 m0, s4, 19456
    ds_read_b64_tr_b16 v[188:189], v255 offset:0
    v_mfma_f32_16x16x32_bf16 v[76:79], v[204:207], a[136:139], v[76:79]
    ds_read_b64_tr_b16 v[190:191], v255 offset:2048
    buffer_load_dwordx4 v248, s[24:27], s39 offen  lds
    v_mfma_f32_16x16x32_bf16 v[60:63], v[204:207], a[132:135], v[60:63]
    v_add_u32 v248, 0x8000, v248
    v_and_b32 v248, 0x7ffff, v248
    v_mfma_f32_16x16x32_bf16 v[44:47], v[204:207], a[128:131], v[44:47]
    v_mfma_f32_16x16x32_bf16 v[28:31], v[204:207], a[124:127], v[28:31]
    s_waitcnt lgkmcnt(2)
    v_mfma_f32_16x16x32_bf16 v[16:19], v[176:179], a[104:107], v[16:19]
    s_add_u32 m0, s4, 0
    s_waitcnt vmcnt(12)
    ds_read_b64_tr_b16 v[192:193], v252 offset:4096
    v_mfma_f32_16x16x32_bf16 v[32:35], v[176:179], a[108:111], v[32:35]
    ds_read_b64_tr_b16 v[194:195], v252 offset:6144
    ds_read_b128 a[124:127], v2 offset:5120
    v_mfma_f32_16x16x32_bf16 v[48:51], v[176:179], a[112:115], v[48:51]
    ds_read_b128 a[128:131], v2 offset:6144
    s_waitcnt lgkmcnt(4)
    buffer_load_dwordx4 v248, s[24:27], 0 offen  lds
    v_mfma_f32_16x16x32_bf16 v[64:67], v[176:179], a[116:119], v[64:67]
    v_mfma_f32_16x16x32_bf16 v[80:83], v[176:179], a[120:123], v[80:83]
    v_mfma_f32_16x16x32_bf16 v[84:87], v[180:183], a[120:123], v[84:87]
    s_add_u32 m0, s4, 1024
    ds_read_b64_tr_b16 v[196:197], v253 offset:4096
    v_mfma_f32_16x16x32_bf16 v[68:71], v[180:183], a[116:119], v[68:71]
    ds_read_b64_tr_b16 v[198:199], v253 offset:6144
    ds_read_b128 a[132:135], v2 offset:7168
    v_mfma_f32_16x16x32_bf16 v[52:55], v[180:183], a[112:115], v[52:55]
    ds_read_b128 a[136:139], v2 offset:8192
    buffer_load_dwordx4 v248, s[24:27], s37 offen  lds
    v_mfma_f32_16x16x32_bf16 v[36:39], v[180:183], a[108:111], v[36:39]
    v_mfma_f32_16x16x32_bf16 v[20:23], v[180:183], a[104:107], v[20:23]
    v_mfma_f32_16x16x32_bf16 v[24:27], v[184:187], a[104:107], v[24:27]
    s_add_u32 m0, s4, 2048
    ds_read_b64_tr_b16 v[200:201], v254 offset:4096
    v_mfma_f32_16x16x32_bf16 v[40:43], v[184:187], a[108:111], v[40:43]
    ds_read_b64_tr_b16 v[202:203], v254 offset:6144
    ds_read_b128 a[140:143], v2 offset:9216
    v_mfma_f32_16x16x32_bf16 v[56:59], v[184:187], a[112:115], v[56:59]
    buffer_load_dwordx4 v248, s[24:27], s38 offen  lds
    v_mfma_f32_16x16x32_bf16 v[72:75], v[184:187], a[116:119], v[72:75]
    v_mfma_f32_16x16x32_bf16 v[88:91], v[184:187], a[120:123], v[88:91]
    v_mfma_f32_16x16x32_bf16 v[92:95], v[188:191], a[120:123], v[92:95]
    s_add_u32 m0, s4, 3072
    ds_read_b64_tr_b16 v[204:205], v255 offset:4096
    v_mfma_f32_16x16x32_bf16 v[76:79], v[188:191], a[116:119], v[76:79]
    ds_read_b64_tr_b16 v[206:207], v255 offset:6144
    buffer_load_dwordx4 v248, s[24:27], s39 offen  lds
    v_mfma_f32_16x16x32_bf16 v[60:63], v[188:191], a[112:115], v[60:63]
    v_add_u32 v248, 0x8000, v248
    v_and_b32 v248, 0x7ffff, v248
    v_mfma_f32_16x16x32_bf16 v[44:47], v[188:191], a[108:111], v[44:47]
    v_mfma_f32_16x16x32_bf16 v[28:31], v[188:191], a[104:107], v[28:31]
    s_waitcnt lgkmcnt(2)
    v_mfma_f32_16x16x32_bf16 v[16:19], v[192:195], a[124:127], v[16:19]
    s_add_u32 m0, s4, 4096
    s_waitcnt vmcnt(12)
    ds_read_b64_tr_b16 v[176:177], v252 offset:8192
    v_mfma_f32_16x16x32_bf16 v[32:35], v[192:195], a[128:131], v[32:35]
    ds_read_b64_tr_b16 v[178:179], v252 offset:10240
    ds_read_b128 a[104:107], v2 offset:10240
    v_mfma_f32_16x16x32_bf16 v[48:51], v[192:195], a[132:135], v[48:51]
    ds_read_b128 a[108:111], v2 offset:11264
    s_waitcnt lgkmcnt(4)
    buffer_load_dwordx4 v248, s[24:27], 0 offen  lds
    v_mfma_f32_16x16x32_bf16 v[64:67], v[192:195], a[136:139], v[64:67]
    v_mfma_f32_16x16x32_bf16 v[80:83], v[192:195], a[140:143], v[80:83]
    v_mfma_f32_16x16x32_bf16 v[84:87], v[196:199], a[140:143], v[84:87]
    s_add_u32 m0, s4, 5120
    ds_read_b64_tr_b16 v[180:181], v253 offset:8192
    v_mfma_f32_16x16x32_bf16 v[68:71], v[196:199], a[136:139], v[68:71]
    ds_read_b64_tr_b16 v[182:183], v253 offset:10240
    ds_read_b128 a[112:115], v2 offset:12288
    v_mfma_f32_16x16x32_bf16 v[52:55], v[196:199], a[132:135], v[52:55]
    ds_read_b128 a[116:119], v2 offset:13312
    buffer_load_dwordx4 v248, s[24:27], s37 offen  lds
    v_mfma_f32_16x16x32_bf16 v[36:39], v[196:199], a[128:131], v[36:39]
    v_mfma_f32_16x16x32_bf16 v[20:23], v[196:199], a[124:127], v[20:23]
    v_mfma_f32_16x16x32_bf16 v[24:27], v[200:203], a[124:127], v[24:27]
    s_add_u32 m0, s4, 6144
    ds_read_b64_tr_b16 v[184:185], v254 offset:8192
    v_mfma_f32_16x16x32_bf16 v[40:43], v[200:203], a[128:131], v[40:43]
    ds_read_b64_tr_b16 v[186:187], v254 offset:10240
    ds_read_b128 a[120:123], v2 offset:14336
    v_mfma_f32_16x16x32_bf16 v[56:59], v[200:203], a[132:135], v[56:59]
    buffer_load_dwordx4 v248, s[24:27], s38 offen  lds
    v_mfma_f32_16x16x32_bf16 v[72:75], v[200:203], a[136:139], v[72:75]
    v_mfma_f32_16x16x32_bf16 v[88:91], v[200:203], a[140:143], v[88:91]
    v_mfma_f32_16x16x32_bf16 v[92:95], v[204:207], a[140:143], v[92:95]
    s_add_u32 m0, s4, 7168
    ds_read_b64_tr_b16 v[188:189], v255 offset:8192
    v_mfma_f32_16x16x32_bf16 v[76:79], v[204:207], a[136:139], v[76:79]
    ds_read_b64_tr_b16 v[190:191], v255 offset:10240
    buffer_load_dwordx4 v248, s[24:27], s39 offen  lds
    v_mfma_f32_16x16x32_bf16 v[60:63], v[204:207], a[132:135], v[60:63]
    v_add_u32 v248, 0x8000, v248
    v_and_b32 v248, 0x7ffff, v248
    v_mfma_f32_16x16x32_bf16 v[44:47], v[204:207], a[128:131], v[44:47]
    v_mfma_f32_16x16x32_bf16 v[28:31], v[204:207], a[124:127], v[28:31]
    s_waitcnt lgkmcnt(2)
    v_mfma_f32_16x16x32_bf16 v[16:19], v[176:179], a[104:107], v[16:19]
    s_add_u32 m0, s4, 8192
    s_waitcnt vmcnt(12)
    ds_read_b64_tr_b16 v[192:193], v252 offset:12288
    v_mfma_f32_16x16x32_bf16 v[32:35], v[176:179], a[108:111], v[32:35]
    ds_read_b64_tr_b16 v[194:195], v252 offset:14336
    ds_read_b128 a[124:127], v2 offset:15360
    v_mfma_f32_16x16x32_bf16 v[48:51], v[176:179], a[112:115], v[48:51]
    ds_read_b128 a[128:131], v2 offset:16384
    s_waitcnt lgkmcnt(4)
    buffer_load_dwordx4 v248, s[24:27], 0 offen  lds
    v_mfma_f32_16x16x32_bf16 v[64:67], v[176:179], a[116:119], v[64:67]
    v_mfma_f32_16x16x32_bf16 v[80:83], v[176:179], a[120:123], v[80:83]
    v_mfma_f32_16x16x32_bf16 v[84:87], v[180:183], a[120:123], v[84:87]
    s_add_u32 m0, s4, 9216
    ds_read_b64_tr_b16 v[196:197], v253 offset:12288
    v_mfma_f32_16x16x32_bf16 v[68:71], v[180:183], a[116:119], v[68:71]
    ds_read_b64_tr_b16 v[198:199], v253 offset:14336
    ds_read_b128 a[132:135], v2 offset:17408
    v_mfma_f32_16x16x32_bf16 v[52:55], v[180:183], a[112:115], v[52:55]
    ds_read_b128 a[136:139], v2 offset:18432
    buffer_load_dwordx4 v248, s[24:27], s37 offen  lds
    v_mfma_f32_16x16x32_bf16 v[36:39], v[180:183], a[108:111], v[36:39]
    v_mfma_f32_16x16x32_bf16 v[20:23], v[180:183], a[104:107], v[20:23]
    v_mfma_f32_16x16x32_bf16 v[24:27], v[184:187], a[104:107], v[24:27]
    s_add_u32 m0, s4, 10240
    ds_read_b64_tr_b16 v[200:201], v254 offset:12288
    v_mfma_f32_16x16x32_bf16 v[40:43], v[184:187], a[108:111], v[40:43]
    ds_read_b64_tr_b16 v[202:203], v254 offset:14336
    ds_read_b128 a[140:143], v2 offset:19456
    v_mfma_f32_16x16x32_bf16 v[56:59], v[184:187], a[112:115], v[56:59]
    buffer_load_dwordx4 v248, s[24:27], s38 offen  lds
    v_mfma_f32_16x16x32_bf16 v[72:75], v[184:187], a[116:119], v[72:75]
    v_mfma_f32_16x16x32_bf16 v[88:91], v[184:187], a[120:123], v[88:91]
    v_mfma_f32_16x16x32_bf16 v[92:95], v[188:191], a[120:123], v[92:95]
    s_add_u32 m0, s4, 11264
    ds_read_b64_tr_b16 v[204:205], v255 offset:12288
    v_mfma_f32_16x16x32_bf16 v[76:79], v[188:191], a[116:119], v[76:79]
    ds_read_b64_tr_b16 v[206:207], v255 offset:14336
    buffer_load_dwordx4 v248, s[24:27], s39 offen  lds
    v_mfma_f32_16x16x32_bf16 v[60:63], v[188:191], a[112:115], v[60:63]
    v_add_u32 v248, 0x8000, v248
    v_and_b32 v248, 0x7ffff, v248
    v_mfma_f32_16x16x32_bf16 v[44:47], v[188:191], a[108:111], v[44:47]
    v_xor_b32 v248, 128, v248
    v_mfma_f32_16x16x32_bf16 v[28:31], v[188:191], a[104:107], v[28:31]
    s_waitcnt lgkmcnt(2)
    v_mfma_f32_16x16x32_bf16 v[16:19], v[192:195], a[124:127], v[16:19]
    s_add_u32 m0, s4, 12288
    s_waitcnt vmcnt(12)
    ds_read_b64_tr_b16 v[176:177], v252 offset:16384
    v_mfma_f32_16x16x32_bf16 v[32:35], v[192:195], a[128:131], v[32:35]
    ds_read_b64_tr_b16 v[178:179], v252 offset:18432
    ds_read_b128 a[104:107], v2 offset:20480
    v_mfma_f32_16x16x32_bf16 v[48:51], v[192:195], a[132:135], v[48:51]
    ds_read_b128 a[108:111], v2 offset:21504
    s_waitcnt lgkmcnt(4)
    buffer_load_dwordx4 v248, s[24:27], 0 offen  lds
    v_mfma_f32_16x16x32_bf16 v[64:67], v[192:195], a[136:139], v[64:67]
    v_mfma_f32_16x16x32_bf16 v[80:83], v[192:195], a[140:143], v[80:83]
    v_mfma_f32_16x16x32_bf16 v[84:87], v[196:199], a[140:143], v[84:87]
    s_add_u32 m0, s4, 13312
    ds_read_b64_tr_b16 v[180:181], v253 offset:16384
    v_mfma_f32_16x16x32_bf16 v[68:71], v[196:199], a[136:139], v[68:71]
    ds_read_b64_tr_b16 v[182:183], v253 offset:18432
    ds_read_b128 a[112:115], v2 offset:22528
    v_mfma_f32_16x16x32_bf16 v[52:55], v[196:199], a[132:135], v[52:55]
    ds_read_b128 a[116:119], v2 offset:23552
    buffer_load_dwordx4 v248, s[24:27], s37 offen  lds
    v_mfma_f32_16x16x32_bf16 v[36:39], v[196:199], a[128:131], v[36:39]
    v_mfma_f32_16x16x32_bf16 v[20:23], v[196:199], a[124:127], v[20:23]
    v_mfma_f32_16x16x32_bf16 v[24:27], v[200:203], a[124:127], v[24:27]
    s_add_u32 m0, s4, 14336
    ds_read_b64_tr_b16 v[184:185], v254 offset:16384
    v_mfma_f32_16x16x32_bf16 v[40:43], v[200:203], a[128:131], v[40:43]
    ds_read_b64_tr_b16 v[186:187], v254 offset:18432
    ds_read_b128 a[120:123], v2 offset:24576
    v_mfma_f32_16x16x32_bf16 v[56:59], v[200:203], a[132:135], v[56:59]
    buffer_load_dwordx4 v248, s[24:27], s38 offen  lds
    v_mfma_f32_16x16x32_bf16 v[72:75], v[200:203], a[136:139], v[72:75]
    v_mfma_f32_16x16x32_bf16 v[88:91], v[200:203], a[140:143], v[88:91]
    v_mfma_f32_16x16x32_bf16 v[92:95], v[204:207], a[140:143], v[92:95]
    s_add_u32 m0, s4, 15360
    ds_read_b64_tr_b16 v[188:189], v255 offset:16384
    v_mfma_f32_16x16x32_bf16 v[76:79], v[204:207], a[136:139], v[76:79]
    ds_read_b64_tr_b16 v[190:191], v255 offset:18432
    buffer_load_dwordx4 v248, s[24:27], s39 offen  lds
    v_mfma_f32_16x16x32_bf16 v[60:63], v[204:207], a[132:135], v[60:63]
    v_add_u32 v248, 0x8000, v248
    v_and_b32 v248, 0x7ffff, v248
    v_mfma_f32_16x16x32_bf16 v[44:47], v[204:207], a[128:131], v[44:47]
    v_mfma_f32_16x16x32_bf16 v[28:31], v[204:207], a[124:127], v[28:31]
    s_waitcnt lgkmcnt(2)
    v_mfma_f32_16x16x32_bf16 v[16:19], v[176:179], a[104:107], v[16:19]
    s_add_u32 m0, s4, 16384
    s_waitcnt vmcnt(12)
    ds_read_b64_tr_b16 v[192:193], v252 offset:0
    v_mfma_f32_16x16x32_bf16 v[32:35], v[176:179], a[108:111], v[32:35]
    ds_read_b64_tr_b16 v[194:195], v252 offset:2048
    ds_read_b128 a[124:127], v2 offset:25600
    v_mfma_f32_16x16x32_bf16 v[48:51], v[176:179], a[112:115], v[48:51]
    ds_read_b128 a[128:131], v2 offset:26624
    s_waitcnt lgkmcnt(4)
    buffer_load_dwordx4 v248, s[24:27], 0 offen  lds
    v_mfma_f32_16x16x32_bf16 v[64:67], v[176:179], a[116:119], v[64:67]
    v_mfma_f32_16x16x32_bf16 v[80:83], v[176:179], a[120:123], v[80:83]
    v_mfma_f32_16x16x32_bf16 v[84:87], v[180:183], a[120:123], v[84:87]
    s_add_u32 m0, s4, 17408
    ds_read_b64_tr_b16 v[196:197], v253 offset:0
    v_mfma_f32_16x16x32_bf16 v[68:71], v[180:183], a[116:119], v[68:71]
    ds_read_b64_tr_b16 v[198:199], v253 offset:2048
    ds_read_b128 a[132:135], v2 offset:27648
    v_mfma_f32_16x16x32_bf16 v[52:55], v[180:183], a[112:115], v[52:55]
    ds_read_b128 a[136:139], v2 offset:28672
    buffer_load_dwordx4 v248, s[24:27], s37 offen  lds
    v_mfma_f32_16x16x32_bf16 v[36:39], v[180:183], a[108:111], v[36:39]
    v_mfma_f32_16x16x32_bf16 v[20:23], v[180:183], a[104:107], v[20:23]
    v_mfma_f32_16x16x32_bf16 v[24:27], v[184:187], a[104:107], v[24:27]
    s_add_u32 m0, s4, 18432
    ds_read_b64_tr_b16 v[200:201], v254 offset:0
    v_mfma_f32_16x16x32_bf16 v[40:43], v[184:187], a[108:111], v[40:43]
    ds_read_b64_tr_b16 v[202:203], v254 offset:2048
    ds_read_b128 a[140:143], v2 offset:29696
    v_mfma_f32_16x16x32_bf16 v[56:59], v[184:187], a[112:115], v[56:59]
    buffer_load_dwordx4 v248, s[24:27], s38 offen  lds
    v_mfma_f32_16x16x32_bf16 v[72:75], v[184:187], a[116:119], v[72:75]
    v_mfma_f32_16x16x32_bf16 v[88:91], v[184:187], a[120:123], v[88:91]
    v_mfma_f32_16x16x32_bf16 v[92:95], v[188:191], a[120:123], v[92:95]
    s_add_u32 m0, s4, 19456
    ds_read_b64_tr_b16 v[204:205], v255 offset:0
    v_mfma_f32_16x16x32_bf16 v[76:79], v[188:191], a[116:119], v[76:79]
    ds_read_b64_tr_b16 v[206:207], v255 offset:2048
    buffer_load_dwordx4 v248, s[24:27], s39 offen  lds
    v_mfma_f32_16x16x32_bf16 v[60:63], v[188:191], a[112:115], v[60:63]
    v_add_u32 v248, 0x8000, v248
    v_and_b32 v248, 0x7ffff, v248
    v_mfma_f32_16x16x32_bf16 v[44:47], v[188:191], a[108:111], v[44:47]
    v_mfma_f32_16x16x32_bf16 v[28:31], v[188:191], a[104:107], v[28:31]
    s_waitcnt lgkmcnt(2)
    v_mfma_f32_16x16x32_bf16 v[16:19], v[192:195], a[124:127], v[16:19]
    s_add_u32 m0, s4, 0
    s_waitcnt vmcnt(12)
    ds_read_b64_tr_b16 v[176:177], v252 offset:4096
    v_mfma_f32_16x16x32_bf16 v[32:35], v[192:195], a[128:131], v[32:35]
    ds_read_b64_tr_b16 v[178:179], v252 offset:6144
    ds_read_b128 a[104:107], v2 offset:30720
    v_mfma_f32_16x16x32_bf16 v[48:51], v[192:195], a[132:135], v[48:51]
    ds_read_b128 a[108:111], v2 offset:31744
    s_waitcnt lgkmcnt(4)
    buffer_load_dwordx4 v248, s[24:27], 0 offen  lds
    v_mfma_f32_16x16x32_bf16 v[64:67], v[192:195], a[136:139], v[64:67]
    v_mfma_f32_16x16x32_bf16 v[80:83], v[192:195], a[140:143], v[80:83]
    v_mfma_f32_16x16x32_bf16 v[84:87], v[196:199], a[140:143], v[84:87]
    s_add_u32 m0, s4, 1024
    ds_read_b64_tr_b16 v[180:181], v253 offset:4096
    v_mfma_f32_16x16x32_bf16 v[68:71], v[196:199], a[136:139], v[68:71]
    ds_read_b64_tr_b16 v[182:183], v253 offset:6144
    ds_read_b128 a[112:115], v2 offset:32768
    v_mfma_f32_16x16x32_bf16 v[52:55], v[196:199], a[132:135], v[52:55]
    ds_read_b128 a[116:119], v2 offset:33792
    buffer_load_dwordx4 v248, s[24:27], s37 offen  lds
    v_mfma_f32_16x16x32_bf16 v[36:39], v[196:199], a[128:131], v[36:39]
    v_mfma_f32_16x16x32_bf16 v[20:23], v[196:199], a[124:127], v[20:23]
    v_mfma_f32_16x16x32_bf16 v[24:27], v[200:203], a[124:127], v[24:27]
    s_add_u32 m0, s4, 2048
    ds_read_b64_tr_b16 v[184:185], v254 offset:4096
    v_mfma_f32_16x16x32_bf16 v[40:43], v[200:203], a[128:131], v[40:43]
    ds_read_b64_tr_b16 v[186:187], v254 offset:6144
    ds_read_b128 a[120:123], v2 offset:34816
    v_mfma_f32_16x16x32_bf16 v[56:59], v[200:203], a[132:135], v[56:59]
    buffer_load_dwordx4 v248, s[24:27], s38 offen  lds
    v_mfma_f32_16x16x32_bf16 v[72:75], v[200:203], a[136:139], v[72:75]
    v_mfma_f32_16x16x32_bf16 v[88:91], v[200:203], a[140:143], v[88:91]
    v_mfma_f32_16x16x32_bf16 v[92:95], v[204:207], a[140:143], v[92:95]
    s_add_u32 m0, s4, 3072
    ds_read_b64_tr_b16 v[188:189], v255 offset:4096
    v_mfma_f32_16x16x32_bf16 v[76:79], v[204:207], a[136:139], v[76:79]
    ds_read_b64_tr_b16 v[190:191], v255 offset:6144
    buffer_load_dwordx4 v248, s[24:27], s39 offen  lds
    v_mfma_f32_16x16x32_bf16 v[60:63], v[204:207], a[132:135], v[60:63]
    v_add_u32 v248, 0x8000, v248
    v_and_b32 v248, 0x7ffff, v248
    v_mfma_f32_16x16x32_bf16 v[44:47], v[204:207], a[128:131], v[44:47]
    v_mfma_f32_16x16x32_bf16 v[28:31], v[204:207], a[124:127], v[28:31]
    s_waitcnt lgkmcnt(2)
    v_mfma_f32_16x16x32_bf16 v[16:19], v[176:179], a[104:107], v[16:19]
    s_add_u32 m0, s4, 4096
    s_waitcnt vmcnt(12)
    ds_read_b64_tr_b16 v[192:193], v252 offset:8192
    v_mfma_f32_16x16x32_bf16 v[32:35], v[176:179], a[108:111], v[32:35]
    ds_read_b64_tr_b16 v[194:195], v252 offset:10240
    ds_read_b128 a[124:127], v2 offset:35840
    v_mfma_f32_16x16x32_bf16 v[48:51], v[176:179], a[112:115], v[48:51]
    ds_read_b128 a[128:131], v2 offset:36864
    s_waitcnt lgkmcnt(4)
    buffer_load_dwordx4 v248, s[24:27], 0 offen  lds
    v_mfma_f32_16x16x32_bf16 v[64:67], v[176:179], a[116:119], v[64:67]
    v_mfma_f32_16x16x32_bf16 v[80:83], v[176:179], a[120:123], v[80:83]
    v_mfma_f32_16x16x32_bf16 v[84:87], v[180:183], a[120:123], v[84:87]
    s_add_u32 m0, s4, 5120
    ds_read_b64_tr_b16 v[196:197], v253 offset:8192
    v_mfma_f32_16x16x32_bf16 v[68:71], v[180:183], a[116:119], v[68:71]
    ds_read_b64_tr_b16 v[198:199], v253 offset:10240
    ds_read_b128 a[132:135], v2 offset:37888
    v_mfma_f32_16x16x32_bf16 v[52:55], v[180:183], a[112:115], v[52:55]
    ds_read_b128 a[136:139], v2 offset:38912
    buffer_load_dwordx4 v248, s[24:27], s37 offen  lds
    v_mfma_f32_16x16x32_bf16 v[36:39], v[180:183], a[108:111], v[36:39]
    v_mfma_f32_16x16x32_bf16 v[20:23], v[180:183], a[104:107], v[20:23]
    v_mfma_f32_16x16x32_bf16 v[24:27], v[184:187], a[104:107], v[24:27]
    s_add_u32 m0, s4, 6144
    ds_read_b64_tr_b16 v[200:201], v254 offset:8192
    v_mfma_f32_16x16x32_bf16 v[40:43], v[184:187], a[108:111], v[40:43]
    ds_read_b64_tr_b16 v[202:203], v254 offset:10240
    ds_read_b128 a[140:143], v2 offset:39936
    v_mfma_f32_16x16x32_bf16 v[56:59], v[184:187], a[112:115], v[56:59]
    buffer_load_dwordx4 v248, s[24:27], s38 offen  lds
    v_mfma_f32_16x16x32_bf16 v[72:75], v[184:187], a[116:119], v[72:75]
    v_mfma_f32_16x16x32_bf16 v[88:91], v[184:187], a[120:123], v[88:91]
    v_mfma_f32_16x16x32_bf16 v[92:95], v[188:191], a[120:123], v[92:95]
    s_add_u32 m0, s4, 7168
    ds_read_b64_tr_b16 v[204:205], v255 offset:8192
    v_mfma_f32_16x16x32_bf16 v[76:79], v[188:191], a[116:119], v[76:79]
    ds_read_b64_tr_b16 v[206:207], v255 offset:10240
    buffer_load_dwordx4 v248, s[24:27], s39 offen  lds
    v_mfma_f32_16x16x32_bf16 v[60:63], v[188:191], a[112:115], v[60:63]
    v_add_u32 v248, 0x8000, v248
    v_and_b32 v248, 0x7ffff, v248
    v_mfma_f32_16x16x32_bf16 v[44:47], v[188:191], a[108:111], v[44:47]
    v_mfma_f32_16x16x32_bf16 v[28:31], v[188:191], a[104:107], v[28:31]
    s_waitcnt lgkmcnt(2)
    v_mfma_f32_16x16x32_bf16 v[16:19], v[192:195], a[124:127], v[16:19]
    s_add_u32 m0, s4, 8192
    s_waitcnt vmcnt(12)
    ds_read_b64_tr_b16 v[176:177], v252 offset:12288
    v_mfma_f32_16x16x32_bf16 v[32:35], v[192:195], a[128:131], v[32:35]
    ds_read_b64_tr_b16 v[178:179], v252 offset:14336
    s_waitcnt lgkmcnt(2)
    buffer_load_dwordx4 v248, s[24:27], 0 offen  lds
    v_mfma_f32_16x16x32_bf16 v[48:51], v[192:195], a[132:135], v[48:51]
    v_subrev_u32 v2, 40960, v2
    v_mfma_f32_16x16x32_bf16 v[64:67], v[192:195], a[136:139], v[64:67]
    ds_read_b128 a[104:107], v2 offset:0
    ds_read_b128 a[108:111], v2 offset:1024
    v_mfma_f32_16x16x32_bf16 v[80:83], v[192:195], a[140:143], v[80:83]
    v_mfma_f32_16x16x32_bf16 v[84:87], v[196:199], a[140:143], v[84:87]
    s_add_u32 m0, s4, 9216
    ds_read_b64_tr_b16 v[180:181], v253 offset:12288
    v_mfma_f32_16x16x32_bf16 v[68:71], v[196:199], a[136:139], v[68:71]
    ds_read_b64_tr_b16 v[182:183], v253 offset:14336
    ds_read_b128 a[112:115], v2 offset:2048
    v_mfma_f32_16x16x32_bf16 v[52:55], v[196:199], a[132:135], v[52:55]
    ds_read_b128 a[116:119], v2 offset:3072
    buffer_load_dwordx4 v248, s[24:27], s37 offen  lds
    v_mfma_f32_16x16x32_bf16 v[36:39], v[196:199], a[128:131], v[36:39]
    v_mfma_f32_16x16x32_bf16 v[20:23], v[196:199], a[124:127], v[20:23]
    v_mfma_f32_16x16x32_bf16 v[24:27], v[200:203], a[124:127], v[24:27]
    s_add_u32 m0, s4, 10240
    ds_read_b64_tr_b16 v[184:185], v254 offset:12288
    v_mfma_f32_16x16x32_bf16 v[40:43], v[200:203], a[128:131], v[40:43]
    ds_read_b64_tr_b16 v[186:187], v254 offset:14336
    ds_read_b128 a[120:123], v2 offset:4096
    v_mfma_f32_16x16x32_bf16 v[56:59], v[200:203], a[132:135], v[56:59]
    buffer_load_dwordx4 v248, s[24:27], s38 offen  lds
    v_mfma_f32_16x16x32_bf16 v[72:75], v[200:203], a[136:139], v[72:75]
    v_mfma_f32_16x16x32_bf16 v[88:91], v[200:203], a[140:143], v[88:91]
    v_mfma_f32_16x16x32_bf16 v[92:95], v[204:207], a[140:143], v[92:95]
    s_add_u32 m0, s4, 11264
    ds_read_b64_tr_b16 v[188:189], v255 offset:12288
    v_mfma_f32_16x16x32_bf16 v[76:79], v[204:207], a[136:139], v[76:79]
    ds_read_b64_tr_b16 v[190:191], v255 offset:14336
    buffer_load_dwordx4 v248, s[24:27], s39 offen  lds
    v_mfma_f32_16x16x32_bf16 v[60:63], v[204:207], a[132:135], v[60:63]
    v_add_u32 v248, 0x8000, v248
    v_and_b32 v248, 0x7ffff, v248
    v_mfma_f32_16x16x32_bf16 v[44:47], v[204:207], a[128:131], v[44:47]
    v_mfma_f32_16x16x32_bf16 v[28:31], v[204:207], a[124:127], v[28:31]
    s_waitcnt lgkmcnt(2)
    v_mfma_f32_16x16x32_bf16 v[96:99], v[176:179], a[104:107], 0
    s_add_u32 m0, s4, 12288
    s_waitcnt vmcnt(12)
    ds_read_b64_tr_b16 v[192:193], v252 offset:16384
    v_mfma_f32_16x16x32_bf16 v[112:115], v[176:179], a[108:111], 0
    ds_read_b64_tr_b16 v[194:195], v252 offset:18432
    ds_read_b128 a[124:127], v2 offset:5120
    v_mfma_f32_16x16x32_bf16 v[128:131], v[176:179], a[112:115], 0
    ds_read_b128 a[128:131], v2 offset:6144
    s_waitcnt lgkmcnt(4)
    buffer_load_dwordx4 v248, s[24:27], 0 offen  lds
    v_mfma_f32_16x16x32_bf16 v[144:147], v[176:179], a[116:119], 0
    v_mfma_f32_16x16x32_bf16 v[160:163], v[176:179], a[120:123], 0
    v_mfma_f32_16x16x32_bf16 v[164:167], v[180:183], a[120:123], 0
    s_add_u32 m0, s4, 13312
    ds_read_b64_tr_b16 v[196:197], v253 offset:16384
    v_mfma_f32_16x16x32_bf16 v[148:151], v[180:183], a[116:119], 0
    ds_read_b64_tr_b16 v[198:199], v253 offset:18432
    ds_read_b128 a[132:135], v2 offset:7168
    v_mfma_f32_16x16x32_bf16 v[132:135], v[180:183], a[112:115], 0
    ds_read_b128 a[136:139], v2 offset:8192
    buffer_load_dwordx4 v248, s[24:27], s37 offen  lds
    v_mfma_f32_16x16x32_bf16 v[116:119], v[180:183], a[108:111], 0
    v_mfma_f32_16x16x32_bf16 v[100:103], v[180:183], a[104:107], 0
    v_mfma_f32_16x16x32_bf16 v[104:107], v[184:187], a[104:107], 0
    s_add_u32 m0, s4, 14336
    ds_read_b64_tr_b16 v[200:201], v254 offset:16384
    v_mfma_f32_16x16x32_bf16 v[120:123], v[184:187], a[108:111], 0
    ds_read_b64_tr_b16 v[202:203], v254 offset:18432
    ds_read_b128 a[140:143], v2 offset:9216
    v_mfma_f32_16x16x32_bf16 v[136:139], v[184:187], a[112:115], 0
    buffer_load_dwordx4 v248, s[24:27], s38 offen  lds
    v_mfma_f32_16x16x32_bf16 v[152:155], v[184:187], a[116:119], 0
    v_mfma_f32_16x16x32_bf16 v[168:171], v[184:187], a[120:123], 0
    v_mfma_f32_16x16x32_bf16 v[172:175], v[188:191], a[120:123], 0
    s_add_u32 m0, s4, 15360
    ds_read_b64_tr_b16 v[204:205], v255 offset:16384
    v_mfma_f32_16x16x32_bf16 v[156:159], v[188:191], a[116:119], 0
    ds_read_b64_tr_b16 v[206:207], v255 offset:18432
    buffer_load_dwordx4 v248, s[24:27], s39 offen  lds
    v_mfma_f32_16x16x32_bf16 v[140:143], v[188:191], a[112:115], 0
    s_add_u32 s7, s59, 0
    v_add_u32 v248, 0x8000, v248
    v_mfma_f32_16x16x32_bf16 v[124:127], v[188:191], a[108:111], 0
    v_and_b32 v248, 0x7ffff, v248
    v_cvt_pk_bf16_f32 v16, v16, v17
    v_mfma_f32_16x16x32_bf16 v[108:111], v[188:191], a[104:107], 0
    v_cvt_pk_bf16_f32 v17, v18, v19
    v_cvt_pk_bf16_f32 v18, v20, v21
    s_waitcnt lgkmcnt(2)
    v_mfma_f32_16x16x32_bf16 v[96:99], v[192:195], a[124:127], v[96:99]
    s_add_u32 m0, s4, 16384
    s_waitcnt vmcnt(12)
    ds_read_b64_tr_b16 v[176:177], v252 offset:0
    v_mfma_f32_16x16x32_bf16 v[112:115], v[192:195], a[128:131], v[112:115]
    ds_read_b64_tr_b16 v[178:179], v252 offset:2048
    ds_read_b128 a[104:107], v2 offset:10240
    v_mfma_f32_16x16x32_bf16 v[128:131], v[192:195], a[132:135], v[128:131]
    ds_read_b128 a[108:111], v2 offset:11264
    s_waitcnt lgkmcnt(4)
    buffer_load_dwordx4 v248, s[24:27], 0 offen  lds
    v_mfma_f32_16x16x32_bf16 v[144:147], v[192:195], a[136:139], v[144:147]
    v_cvt_pk_bf16_f32 v19, v22, v23
    v_cvt_pk_bf16_f32 v32, v32, v33
    v_mfma_f32_16x16x32_bf16 v[160:163], v[192:195], a[140:143], v[160:163]
    buffer_store_dwordx4 v[16:19], v5, s[28:31], s7 offen sc1
    v_cvt_pk_bf16_f32 v33, v34, v35
    v_mfma_f32_16x16x32_bf16 v[164:167], v[196:199], a[140:143], v[164:167]
    s_add_u32 m0, s4, 17408
    ds_read_b64_tr_b16 v[180:181], v253 offset:0
    v_mfma_f32_16x16x32_bf16 v[148:151], v[196:199], a[136:139], v[148:151]
    ds_read_b64_tr_b16 v[182:183], v253 offset:2048
    ds_read_b128 a[112:115], v2 offset:12288
    v_mfma_f32_16x16x32_bf16 v[132:135], v[196:199], a[132:135], v[132:135]
    ds_read_b128 a[116:119], v2 offset:13312
    buffer_load_dwordx4 v248, s[24:27], s37 offen  lds
    v_mfma_f32_16x16x32_bf16 v[116:119], v[196:199], a[128:131], v[116:119]
    s_add_u32 s7, s59, 1024
    v_cvt_pk_bf16_f32 v34, v36, v37
    v_mfma_f32_16x16x32_bf16 v[100:103], v[196:199], a[124:127], v[100:103]
    v_cvt_pk_bf16_f32 v35, v38, v39
    buffer_store_dwordx4 v[32:35], v5, s[28:31], s7 offen sc1
    v_mfma_f32_16x16x32_bf16 v[104:107], v[200:203], a[124:127], v[104:107]
    s_add_u32 m0, s4, 18432
    ds_read_b64_tr_b16 v[184:185], v254 offset:0
    v_mfma_f32_16x16x32_bf16 v[120:123], v[200:203], a[128:131], v[120:123]
    ds_read_b64_tr_b16 v[186:187], v254 offset:2048
    ds_read_b128 a[120:123], v2 offset:14336
    v_mfma_f32_16x16x32_bf16 v[136:139], v[200:203], a[132:135], v[136:139]
    buffer_load_dwordx4 v248, s[24:27], s38 offen  lds
    s_add_u32 s7, s59, 2048
    v_mfma_f32_16x16x32_bf16 v[152:155], v[200:203], a[136:139], v[152:155]
    v_cvt_pk_bf16_f32 v48, v48, v49
    v_cvt_pk_bf16_f32 v49, v50, v51
    v_mfma_f32_16x16x32_bf16 v[168:171], v[200:203], a[140:143], v[168:171]
    v_cvt_pk_bf16_f32 v50, v52, v53
    v_cvt_pk_bf16_f32 v51, v54, v55
    v_mfma_f32_16x16x32_bf16 v[172:175], v[204:207], a[140:143], v[172:175]
    s_add_u32 m0, s4, 19456
    ds_read_b64_tr_b16 v[188:189], v255 offset:0
    v_mfma_f32_16x16x32_bf16 v[156:159], v[204:207], a[136:139], v[156:159]
    ds_read_b64_tr_b16 v[190:191], v255 offset:2048
    buffer_load_dwordx4 v248, s[24:27], s39 offen  lds
    v_mfma_f32_16x16x32_bf16 v[140:143], v[204:207], a[132:135], v[140:143]
    buffer_store_dwordx4 v[48:51], v5, s[28:31], s7 offen sc1
    s_add_u32 s7, s59, 3072
    v_mfma_f32_16x16x32_bf16 v[124:127], v[204:207], a[128:131], v[124:127]
    v_add_u32 v248, 0x8000, v248
    v_and_b32 v248, 0x7ffff, v248
    v_mfma_f32_16x16x32_bf16 v[108:111], v[204:207], a[124:127], v[108:111]
    v_cvt_pk_bf16_f32 v64, v64, v65
    v_cvt_pk_bf16_f32 v65, v66, v67
    s_waitcnt lgkmcnt(2)
    v_mfma_f32_16x16x32_bf16 v[96:99], v[176:179], a[104:107], v[96:99]
    s_add_u32 m0, s4, 0
    s_waitcnt vmcnt(15)
    ds_read_b64_tr_b16 v[192:193], v252 offset:4096
    v_mfma_f32_16x16x32_bf16 v[112:115], v[176:179], a[108:111], v[112:115]
    ds_read_b64_tr_b16 v[194:195], v252 offset:6144
    ds_read_b128 a[124:127], v2 offset:15360
    v_mfma_f32_16x16x32_bf16 v[128:131], v[176:179], a[112:115], v[128:131]
    ds_read_b128 a[128:131], v2 offset:16384
    s_waitcnt lgkmcnt(4)
    buffer_load_dwordx4 v248, s[24:27], 0 offen  lds
    v_mfma_f32_16x16x32_bf16 v[144:147], v[176:179], a[116:119], v[144:147]
    v_cvt_pk_bf16_f32 v66, v68, v69
    v_cvt_pk_bf16_f32 v67, v70, v71
    v_mfma_f32_16x16x32_bf16 v[160:163], v[176:179], a[120:123], v[160:163]
    buffer_store_dwordx4 v[64:67], v5, s[28:31], s7 offen sc1
    v_cvt_pk_bf16_f32 v80, v80, v81
    v_mfma_f32_16x16x32_bf16 v[164:167], v[180:183], a[120:123], v[164:167]
    s_add_u32 m0, s4, 1024
    ds_read_b64_tr_b16 v[196:197], v253 offset:4096
    v_mfma_f32_16x16x32_bf16 v[148:151], v[180:183], a[116:119], v[148:151]
    ds_read_b64_tr_b16 v[198:199], v253 offset:6144
    ds_read_b128 a[132:135], v2 offset:17408
    v_mfma_f32_16x16x32_bf16 v[132:135], v[180:183], a[112:115], v[132:135]
    ds_read_b128 a[136:139], v2 offset:18432
    buffer_load_dwordx4 v248, s[24:27], s37 offen  lds
    v_mfma_f32_16x16x32_bf16 v[116:119], v[180:183], a[108:111], v[116:119]
    s_add_u32 s7, s59, 4096
    v_cvt_pk_bf16_f32 v81, v82, v83
    v_mfma_f32_16x16x32_bf16 v[100:103], v[180:183], a[104:107], v[100:103]
    v_cvt_pk_bf16_f32 v82, v84, v85
    v_cvt_pk_bf16_f32 v83, v86, v87
    v_mfma_f32_16x16x32_bf16 v[104:107], v[184:187], a[104:107], v[104:107]
    s_add_u32 m0, s4, 2048
    ds_read_b64_tr_b16 v[200:201], v254 offset:4096
    v_mfma_f32_16x16x32_bf16 v[120:123], v[184:187], a[108:111], v[120:123]
    ds_read_b64_tr_b16 v[202:203], v254 offset:6144
    ds_read_b128 a[140:143], v2 offset:19456
    v_mfma_f32_16x16x32_bf16 v[136:139], v[184:187], a[112:115], v[136:139]
    buffer_load_dwordx4 v248, s[24:27], s38 offen  lds
    buffer_store_dwordx4 v[80:83], v5, s[28:31], s7 offen sc1
    v_mfma_f32_16x16x32_bf16 v[152:155], v[184:187], a[116:119], v[152:155]
    v_mfma_f32_16x16x32_bf16 v[168:171], v[184:187], a[120:123], v[168:171]
    v_mfma_f32_16x16x32_bf16 v[172:175], v[188:191], a[120:123], v[172:175]
    s_add_u32 m0, s4, 3072
    ds_read_b64_tr_b16 v[204:205], v255 offset:4096
    v_mfma_f32_16x16x32_bf16 v[156:159], v[188:191], a[116:119], v[156:159]
    ds_read_b64_tr_b16 v[206:207], v255 offset:6144
    buffer_load_dwordx4 v248, s[24:27], s39 offen  lds
    v_mfma_f32_16x16x32_bf16 v[140:143], v[188:191], a[112:115], v[140:143]
    v_add_u32 v248, 0x8000, v248
    v_and_b32 v248, 0x7ffff, v248
    v_mfma_f32_16x16x32_bf16 v[124:127], v[188:191], a[108:111], v[124:127]
    v_mfma_f32_16x16x32_bf16 v[108:111], v[188:191], a[104:107], v[108:111]
    s_waitcnt lgkmcnt(2)
    v_mfma_f32_16x16x32_bf16 v[96:99], v[192:195], a[124:127], v[96:99]
    s_add_u32 m0, s4, 4096
    s_waitcnt vmcnt(17)
    ds_read_b64_tr_b16 v[176:177], v252 offset:8192
    v_mfma_f32_16x16x32_bf16 v[112:115], v[192:195], a[128:131], v[112:115]
    ds_read_b64_tr_b16 v[178:179], v252 offset:10240
    ds_read_b128 a[104:107], v2 offset:20480
    v_mfma_f32_16x16x32_bf16 v[128:131], v[192:195], a[132:135], v[128:131]
    ds_read_b128 a[108:111], v2 offset:21504
    s_waitcnt lgkmcnt(4)
    buffer_load_dwordx4 v248, s[24:27], 0 offen  lds
    v_mfma_f32_16x16x32_bf16 v[144:147], v[192:195], a[136:139], v[144:147]
    v_mfma_f32_16x16x32_bf16 v[160:163], v[192:195], a[140:143], v[160:163]
    v_mfma_f32_16x16x32_bf16 v[164:167], v[196:199], a[140:143], v[164:167]
    s_add_u32 m0, s4, 5120
    ds_read_b64_tr_b16 v[180:181], v253 offset:8192
    v_mfma_f32_16x16x32_bf16 v[148:151], v[196:199], a[136:139], v[148:151]
    ds_read_b64_tr_b16 v[182:183], v253 offset:10240
    ds_read_b128 a[112:115], v2 offset:22528
    v_mfma_f32_16x16x32_bf16 v[132:135], v[196:199], a[132:135], v[132:135]
    ds_read_b128 a[116:119], v2 offset:23552
    buffer_load_dwordx4 v248, s[24:27], s37 offen  lds
    v_mfma_f32_16x16x32_bf16 v[116:119], v[196:199], a[128:131], v[116:119]
    v_mfma_f32_16x16x32_bf16 v[100:103], v[196:199], a[124:127], v[100:103]
    v_mfma_f32_16x16x32_bf16 v[104:107], v[200:203], a[124:127], v[104:107]
    s_add_u32 m0, s4, 6144
    ds_read_b64_tr_b16 v[184:185], v254 offset:8192
    v_mfma_f32_16x16x32_bf16 v[120:123], v[200:203], a[128:131], v[120:123]
    ds_read_b64_tr_b16 v[186:187], v254 offset:10240
    ds_read_b128 a[120:123], v2 offset:24576
    v_mfma_f32_16x16x32_bf16 v[136:139], v[200:203], a[132:135], v[136:139]
    buffer_load_dwordx4 v248, s[24:27], s38 offen  lds
    v_mfma_f32_16x16x32_bf16 v[152:155], v[200:203], a[136:139], v[152:155]
    v_mfma_f32_16x16x32_bf16 v[168:171], v[200:203], a[140:143], v[168:171]
    v_mfma_f32_16x16x32_bf16 v[172:175], v[204:207], a[140:143], v[172:175]
    s_add_u32 m0, s4, 7168
    ds_read_b64_tr_b16 v[188:189], v255 offset:8192
    v_mfma_f32_16x16x32_bf16 v[156:159], v[204:207], a[136:139], v[156:159]
    ds_read_b64_tr_b16 v[190:191], v255 offset:10240
    buffer_load_dwordx4 v248, s[24:27], s39 offen  lds
    v_mfma_f32_16x16x32_bf16 v[140:143], v[204:207], a[132:135], v[140:143]
    v_add_u32 v248, 0x8000, v248
    v_and_b32 v248, 0x7ffff, v248
    v_mfma_f32_16x16x32_bf16 v[124:127], v[204:207], a[128:131], v[124:127]
    v_mfma_f32_16x16x32_bf16 v[108:111], v[204:207], a[124:127], v[108:111]
    s_waitcnt lgkmcnt(2)
    v_mfma_f32_16x16x32_bf16 v[96:99], v[176:179], a[104:107], v[96:99]
    s_add_u32 m0, s4, 8192
    s_waitcnt vmcnt(17)
    ds_read_b64_tr_b16 v[192:193], v252 offset:12288
    v_mfma_f32_16x16x32_bf16 v[112:115], v[176:179], a[108:111], v[112:115]
    ds_read_b64_tr_b16 v[194:195], v252 offset:14336
    ds_read_b128 a[124:127], v2 offset:25600
    v_mfma_f32_16x16x32_bf16 v[128:131], v[176:179], a[112:115], v[128:131]
    ds_read_b128 a[128:131], v2 offset:26624
    s_waitcnt lgkmcnt(4)
    buffer_load_dwordx4 v248, s[24:27], 0 offen  lds
    v_mfma_f32_16x16x32_bf16 v[144:147], v[176:179], a[116:119], v[144:147]
    v_mfma_f32_16x16x32_bf16 v[160:163], v[176:179], a[120:123], v[160:163]
    v_mfma_f32_16x16x32_bf16 v[164:167], v[180:183], a[120:123], v[164:167]
    s_add_u32 m0, s4, 9216
    ds_read_b64_tr_b16 v[196:197], v253 offset:12288
    v_mfma_f32_16x16x32_bf16 v[148:151], v[180:183], a[116:119], v[148:151]
    ds_read_b64_tr_b16 v[198:199], v253 offset:14336
    ds_read_b128 a[132:135], v2 offset:27648
    v_mfma_f32_16x16x32_bf16 v[132:135], v[180:183], a[112:115], v[132:135]
    ds_read_b128 a[136:139], v2 offset:28672
    buffer_load_dwordx4 v248, s[24:27], s37 offen  lds
    v_mfma_f32_16x16x32_bf16 v[116:119], v[180:183], a[108:111], v[116:119]
    v_mfma_f32_16x16x32_bf16 v[100:103], v[180:183], a[104:107], v[100:103]
    v_mfma_f32_16x16x32_bf16 v[104:107], v[184:187], a[104:107], v[104:107]
    s_add_u32 m0, s4, 10240
    ds_read_b64_tr_b16 v[200:201], v254 offset:12288
    v_mfma_f32_16x16x32_bf16 v[120:123], v[184:187], a[108:111], v[120:123]
    ds_read_b64_tr_b16 v[202:203], v254 offset:14336
    ds_read_b128 a[140:143], v2 offset:29696
    v_mfma_f32_16x16x32_bf16 v[136:139], v[184:187], a[112:115], v[136:139]
    buffer_load_dwordx4 v248, s[24:27], s38 offen  lds
    v_mfma_f32_16x16x32_bf16 v[152:155], v[184:187], a[116:119], v[152:155]
    v_mfma_f32_16x16x32_bf16 v[168:171], v[184:187], a[120:123], v[168:171]
    v_mfma_f32_16x16x32_bf16 v[172:175], v[188:191], a[120:123], v[172:175]
    s_add_u32 m0, s4, 11264
    ds_read_b64_tr_b16 v[204:205], v255 offset:12288
    v_mfma_f32_16x16x32_bf16 v[156:159], v[188:191], a[116:119], v[156:159]
    ds_read_b64_tr_b16 v[206:207], v255 offset:14336
    buffer_load_dwordx4 v248, s[24:27], s39 offen  lds
    v_mfma_f32_16x16x32_bf16 v[140:143], v[188:191], a[112:115], v[140:143]
    v_add_u32 v248, 0x8000, v248
    v_and_b32 v248, 0x7ffff, v248
    v_mfma_f32_16x16x32_bf16 v[124:127], v[188:191], a[108:111], v[124:127]
    v_mfma_f32_16x16x32_bf16 v[108:111], v[188:191], a[104:107], v[108:111]
    s_waitcnt lgkmcnt(2)
    v_mfma_f32_16x16x32_bf16 v[96:99], v[192:195], a[124:127], v[96:99]
    s_add_u32 m0, s4, 12288
    s_waitcnt vmcnt(15)
    ds_read_b64_tr_b16 v[176:177], v252 offset:16384
    v_mfma_f32_16x16x32_bf16 v[112:115], v[192:195], a[128:131], v[112:115]
    ds_read_b64_tr_b16 v[178:179], v252 offset:18432
    ds_read_b128 a[104:107], v2 offset:30720
    v_mfma_f32_16x16x32_bf16 v[128:131], v[192:195], a[132:135], v[128:131]
    ds_read_b128 a[108:111], v2 offset:31744
    s_waitcnt lgkmcnt(4)
    buffer_load_dwordx4 v248, s[24:27], 0 offen  lds
    v_mfma_f32_16x16x32_bf16 v[144:147], v[192:195], a[136:139], v[144:147]
    v_mfma_f32_16x16x32_bf16 v[160:163], v[192:195], a[140:143], v[160:163]
    v_mfma_f32_16x16x32_bf16 v[164:167], v[196:199], a[140:143], v[164:167]
    s_add_u32 m0, s4, 13312
    ds_read_b64_tr_b16 v[180:181], v253 offset:16384
    v_mfma_f32_16x16x32_bf16 v[148:151], v[196:199], a[136:139], v[148:151]
    ds_read_b64_tr_b16 v[182:183], v253 offset:18432
    ds_read_b128 a[112:115], v2 offset:32768
    v_mfma_f32_16x16x32_bf16 v[132:135], v[196:199], a[132:135], v[132:135]
    ds_read_b128 a[116:119], v2 offset:33792
    buffer_load_dwordx4 v248, s[24:27], s37 offen  lds
    v_mfma_f32_16x16x32_bf16 v[116:119], v[196:199], a[128:131], v[116:119]
    v_mfma_f32_16x16x32_bf16 v[100:103], v[196:199], a[124:127], v[100:103]
    v_mfma_f32_16x16x32_bf16 v[104:107], v[200:203], a[124:127], v[104:107]
    s_add_u32 m0, s4, 14336
    ds_read_b64_tr_b16 v[184:185], v254 offset:16384
    v_mfma_f32_16x16x32_bf16 v[120:123], v[200:203], a[128:131], v[120:123]
    ds_read_b64_tr_b16 v[186:187], v254 offset:18432
    ds_read_b128 a[120:123], v2 offset:34816
    v_mfma_f32_16x16x32_bf16 v[136:139], v[200:203], a[132:135], v[136:139]
    buffer_load_dwordx4 v248, s[24:27], s38 offen  lds
    v_mfma_f32_16x16x32_bf16 v[152:155], v[200:203], a[136:139], v[152:155]
    v_mfma_f32_16x16x32_bf16 v[168:171], v[200:203], a[140:143], v[168:171]
    v_mfma_f32_16x16x32_bf16 v[172:175], v[204:207], a[140:143], v[172:175]
    s_add_u32 m0, s4, 15360
    ds_read_b64_tr_b16 v[188:189], v255 offset:16384
    v_mfma_f32_16x16x32_bf16 v[156:159], v[204:207], a[136:139], v[156:159]
    ds_read_b64_tr_b16 v[190:191], v255 offset:18432
    buffer_load_dwordx4 v248, s[24:27], s39 offen  lds
    v_mfma_f32_16x16x32_bf16 v[140:143], v[204:207], a[132:135], v[140:143]
    v_add_u32 v248, 0x8000, v248
    v_and_b32 v248, 0x7ffff, v248
    v_mfma_f32_16x16x32_bf16 v[124:127], v[204:207], a[128:131], v[124:127]
    v_mfma_f32_16x16x32_bf16 v[108:111], v[204:207], a[124:127], v[108:111]
    s_waitcnt lgkmcnt(2)
    v_mfma_f32_16x16x32_bf16 v[96:99], v[176:179], a[104:107], v[96:99]
    s_add_u32 m0, s4, 16384
    s_waitcnt vmcnt(12)
    ds_read_b64_tr_b16 v[192:193], v252 offset:0
    v_mfma_f32_16x16x32_bf16 v[112:115], v[176:179], a[108:111], v[112:115]
    ds_read_b64_tr_b16 v[194:195], v252 offset:2048
    ds_read_b128 a[124:127], v2 offset:35840
    v_mfma_f32_16x16x32_bf16 v[128:131], v[176:179], a[112:115], v[128:131]
    ds_read_b128 a[128:131], v2 offset:36864
    s_waitcnt lgkmcnt(4)
    buffer_load_dwordx4 v248, s[24:27], 0 offen  lds
    v_mfma_f32_16x16x32_bf16 v[144:147], v[176:179], a[116:119], v[144:147]
    v_mfma_f32_16x16x32_bf16 v[160:163], v[176:179], a[120:123], v[160:163]
    v_mfma_f32_16x16x32_bf16 v[164:167], v[180:183], a[120:123], v[164:167]
    s_add_u32 m0, s4, 17408
    ds_read_b64_tr_b16 v[196:197], v253 offset:0
    v_mfma_f32_16x16x32_bf16 v[148:151], v[180:183], a[116:119], v[148:151]
    ds_read_b64_tr_b16 v[198:199], v253 offset:2048
    ds_read_b128 a[132:135], v2 offset:37888
    v_mfma_f32_16x16x32_bf16 v[132:135], v[180:183], a[112:115], v[132:135]
    ds_read_b128 a[136:139], v2 offset:38912
    buffer_load_dwordx4 v248, s[24:27], s37 offen  lds
    v_mfma_f32_16x16x32_bf16 v[116:119], v[180:183], a[108:111], v[116:119]
    v_mfma_f32_16x16x32_bf16 v[100:103], v[180:183], a[104:107], v[100:103]
    v_mfma_f32_16x16x32_bf16 v[104:107], v[184:187], a[104:107], v[104:107]
    s_add_u32 m0, s4, 18432
    ds_read_b64_tr_b16 v[200:201], v254 offset:0
    v_mfma_f32_16x16x32_bf16 v[120:123], v[184:187], a[108:111], v[120:123]
    ds_read_b64_tr_b16 v[202:203], v254 offset:2048
    ds_read_b128 a[140:143], v2 offset:39936
    v_mfma_f32_16x16x32_bf16 v[136:139], v[184:187], a[112:115], v[136:139]
    buffer_load_dwordx4 v248, s[24:27], s38 offen  lds
    v_mfma_f32_16x16x32_bf16 v[152:155], v[184:187], a[116:119], v[152:155]
    v_mfma_f32_16x16x32_bf16 v[168:171], v[184:187], a[120:123], v[168:171]
    v_mfma_f32_16x16x32_bf16 v[172:175], v[188:191], a[120:123], v[172:175]
    s_add_u32 m0, s4, 19456
    ds_read_b64_tr_b16 v[204:205], v255 offset:0
    v_mfma_f32_16x16x32_bf16 v[156:159], v[188:191], a[116:119], v[156:159]
    ds_read_b64_tr_b16 v[206:207], v255 offset:2048
    buffer_load_dwordx4 v248, s[24:27], s39 offen  lds
    v_mfma_f32_16x16x32_bf16 v[140:143], v[188:191], a[112:115], v[140:143]
    v_add_u32 v248, 0x8000, v248
    v_and_b32 v248, 0x7ffff, v248
    v_mfma_f32_16x16x32_bf16 v[124:127], v[188:191], a[108:111], v[124:127]
    v_mfma_f32_16x16x32_bf16 v[108:111], v[188:191], a[104:107], v[108:111]
    s_waitcnt lgkmcnt(2)
    v_mfma_f32_16x16x32_bf16 v[96:99], v[192:195], a[124:127], v[96:99]
    s_add_u32 m0, s4, 0
    s_waitcnt vmcnt(12)
    ds_read_b64_tr_b16 v[176:177], v252 offset:4096
    v_mfma_f32_16x16x32_bf16 v[112:115], v[192:195], a[128:131], v[112:115]
    ds_read_b64_tr_b16 v[178:179], v252 offset:6144
    s_waitcnt lgkmcnt(2)
    buffer_load_dwordx4 v248, s[24:27], 0 offen  lds
    v_mfma_f32_16x16x32_bf16 v[128:131], v[192:195], a[132:135], v[128:131]
    v_add_u32 v2, 40960, v2
    v_mfma_f32_16x16x32_bf16 v[144:147], v[192:195], a[136:139], v[144:147]
    ds_read_b128 a[104:107], v2 offset:0
    ds_read_b128 a[108:111], v2 offset:1024
    v_mfma_f32_16x16x32_bf16 v[160:163], v[192:195], a[140:143], v[160:163]
    v_mfma_f32_16x16x32_bf16 v[164:167], v[196:199], a[140:143], v[164:167]
    s_add_u32 m0, s4, 1024
    ds_read_b64_tr_b16 v[180:181], v253 offset:4096
    v_mfma_f32_16x16x32_bf16 v[148:151], v[196:199], a[136:139], v[148:151]
    ds_read_b64_tr_b16 v[182:183], v253 offset:6144
    ds_read_b128 a[112:115], v2 offset:2048
    v_mfma_f32_16x16x32_bf16 v[132:135], v[196:199], a[132:135], v[132:135]
    ds_read_b128 a[116:119], v2 offset:3072
    buffer_load_dwordx4 v248, s[24:27], s37 offen  lds
    v_mfma_f32_16x16x32_bf16 v[116:119], v[196:199], a[128:131], v[116:119]
    v_mfma_f32_16x16x32_bf16 v[100:103], v[196:199], a[124:127], v[100:103]
    v_mfma_f32_16x16x32_bf16 v[104:107], v[200:203], a[124:127], v[104:107]
    s_add_u32 m0, s4, 2048
    ds_read_b64_tr_b16 v[184:185], v254 offset:4096
    v_mfma_f32_16x16x32_bf16 v[120:123], v[200:203], a[128:131], v[120:123]
    ds_read_b64_tr_b16 v[186:187], v254 offset:6144
    ds_read_b128 a[120:123], v2 offset:4096
    v_mfma_f32_16x16x32_bf16 v[136:139], v[200:203], a[132:135], v[136:139]
    buffer_load_dwordx4 v248, s[24:27], s38 offen  lds
    v_mfma_f32_16x16x32_bf16 v[152:155], v[200:203], a[136:139], v[152:155]
    v_mfma_f32_16x16x32_bf16 v[168:171], v[200:203], a[140:143], v[168:171]
    v_mfma_f32_16x16x32_bf16 v[172:175], v[204:207], a[140:143], v[172:175]
    s_add_u32 m0, s4, 3072
    ds_read_b64_tr_b16 v[188:189], v255 offset:4096
    v_mfma_f32_16x16x32_bf16 v[156:159], v[204:207], a[136:139], v[156:159]
    ds_read_b64_tr_b16 v[190:191], v255 offset:6144
    buffer_load_dwordx4 v248, s[24:27], s39 offen  lds
    v_mfma_f32_16x16x32_bf16 v[140:143], v[204:207], a[132:135], v[140:143]
    v_add_u32 v248, 0x8000, v248
    v_and_b32 v248, 0x7ffff, v248
    v_mfma_f32_16x16x32_bf16 v[124:127], v[204:207], a[128:131], v[124:127]
    v_mfma_f32_16x16x32_bf16 v[108:111], v[204:207], a[124:127], v[108:111]
    s_waitcnt lgkmcnt(2)
    v_mfma_f32_16x16x32_bf16 v[96:99], v[176:179], a[104:107], v[96:99]
    s_add_u32 m0, s4, 4096
    s_waitcnt vmcnt(12)
    ds_read_b64_tr_b16 v[192:193], v252 offset:8192
    v_mfma_f32_16x16x32_bf16 v[112:115], v[176:179], a[108:111], v[112:115]
    ds_read_b64_tr_b16 v[194:195], v252 offset:10240
    ds_read_b128 a[124:127], v2 offset:5120
    v_mfma_f32_16x16x32_bf16 v[128:131], v[176:179], a[112:115], v[128:131]
    ds_read_b128 a[128:131], v2 offset:6144
    s_waitcnt lgkmcnt(4)
    buffer_load_dwordx4 v248, s[24:27], 0 offen  lds
    v_mfma_f32_16x16x32_bf16 v[144:147], v[176:179], a[116:119], v[144:147]
    v_mfma_f32_16x16x32_bf16 v[160:163], v[176:179], a[120:123], v[160:163]
    v_mfma_f32_16x16x32_bf16 v[164:167], v[180:183], a[120:123], v[164:167]
    s_add_u32 m0, s4, 5120
    ds_read_b64_tr_b16 v[196:197], v253 offset:8192
    v_mfma_f32_16x16x32_bf16 v[148:151], v[180:183], a[116:119], v[148:151]
    ds_read_b64_tr_b16 v[198:199], v253 offset:10240
    ds_read_b128 a[132:135], v2 offset:7168
    v_mfma_f32_16x16x32_bf16 v[132:135], v[180:183], a[112:115], v[132:135]
    ds_read_b128 a[136:139], v2 offset:8192
    buffer_load_dwordx4 v248, s[24:27], s37 offen  lds
    v_mfma_f32_16x16x32_bf16 v[116:119], v[180:183], a[108:111], v[116:119]
    v_mfma_f32_16x16x32_bf16 v[100:103], v[180:183], a[104:107], v[100:103]
    v_mfma_f32_16x16x32_bf16 v[104:107], v[184:187], a[104:107], v[104:107]
    s_add_u32 m0, s4, 6144
    ds_read_b64_tr_b16 v[200:201], v254 offset:8192
    v_mfma_f32_16x16x32_bf16 v[120:123], v[184:187], a[108:111], v[120:123]
    ds_read_b64_tr_b16 v[202:203], v254 offset:10240
    ds_read_b128 a[140:143], v2 offset:9216
    v_mfma_f32_16x16x32_bf16 v[136:139], v[184:187], a[112:115], v[136:139]
    buffer_load_dwordx4 v248, s[24:27], s38 offen  lds
    v_mfma_f32_16x16x32_bf16 v[152:155], v[184:187], a[116:119], v[152:155]
    v_mfma_f32_16x16x32_bf16 v[168:171], v[184:187], a[120:123], v[168:171]
    v_mfma_f32_16x16x32_bf16 v[172:175], v[188:191], a[120:123], v[172:175]
    s_add_u32 m0, s4, 7168
    ds_read_b64_tr_b16 v[204:205], v255 offset:8192
    v_mfma_f32_16x16x32_bf16 v[156:159], v[188:191], a[116:119], v[156:159]
    ds_read_b64_tr_b16 v[206:207], v255 offset:10240
    buffer_load_dwordx4 v248, s[24:27], s39 offen  lds
    v_mfma_f32_16x16x32_bf16 v[140:143], v[188:191], a[112:115], v[140:143]
    v_add_u32 v248, 0x8000, v248
    v_and_b32 v248, 0x7ffff, v248
    v_mfma_f32_16x16x32_bf16 v[124:127], v[188:191], a[108:111], v[124:127]
    v_mfma_f32_16x16x32_bf16 v[108:111], v[188:191], a[104:107], v[108:111]
    s_waitcnt lgkmcnt(2)
    v_mfma_f32_16x16x32_bf16 v[96:99], v[192:195], a[124:127], v[96:99]
    s_add_u32 m0, s4, 8192
    s_waitcnt vmcnt(12)
    ds_read_b64_tr_b16 v[176:177], v252 offset:12288
    v_mfma_f32_16x16x32_bf16 v[112:115], v[192:195], a[128:131], v[112:115]
    ds_read_b64_tr_b16 v[178:179], v252 offset:14336
    ds_read_b128 a[104:107], v2 offset:10240
    v_mfma_f32_16x16x32_bf16 v[128:131], v[192:195], a[132:135], v[128:131]
    ds_read_b128 a[108:111], v2 offset:11264
    s_waitcnt lgkmcnt(4)
    buffer_load_dwordx4 v248, s[24:27], 0 offen  lds
    v_mfma_f32_16x16x32_bf16 v[144:147], v[192:195], a[136:139], v[144:147]
    v_mfma_f32_16x16x32_bf16 v[160:163], v[192:195], a[140:143], v[160:163]
    v_mfma_f32_16x16x32_bf16 v[164:167], v[196:199], a[140:143], v[164:167]
    s_add_u32 m0, s4, 9216
    ds_read_b64_tr_b16 v[180:181], v253 offset:12288
    v_mfma_f32_16x16x32_bf16 v[148:151], v[196:199], a[136:139], v[148:151]
    ds_read_b64_tr_b16 v[182:183], v253 offset:14336
    ds_read_b128 a[112:115], v2 offset:12288
    v_mfma_f32_16x16x32_bf16 v[132:135], v[196:199], a[132:135], v[132:135]
    ds_read_b128 a[116:119], v2 offset:13312
    ds_read_b128 a[144:147], v2 offset:25600
    v_mfma_f32_16x16x32_bf16 v[116:119], v[196:199], a[128:131], v[116:119]
    buffer_load_dwordx4 v248, s[24:27], s37 offen  lds
    v_mfma_f32_16x16x32_bf16 v[100:103], v[196:199], a[124:127], v[100:103]
    v_mfma_f32_16x16x32_bf16 v[104:107], v[200:203], a[124:127], v[104:107]
    s_add_u32 m0, s4, 10240
    ds_read_b64_tr_b16 v[184:185], v254 offset:12288
    v_mfma_f32_16x16x32_bf16 v[120:123], v[200:203], a[128:131], v[120:123]
    ds_read_b64_tr_b16 v[186:187], v254 offset:14336
    ds_read_b128 a[120:123], v2 offset:14336
    v_mfma_f32_16x16x32_bf16 v[136:139], v[200:203], a[132:135], v[136:139]
    ds_read_b128 a[148:151], v2 offset:26624
    ds_read_b128 a[152:155], v2 offset:27648
    v_mfma_f32_16x16x32_bf16 v[152:155], v[200:203], a[136:139], v[152:155]
    buffer_load_dwordx4 v248, s[24:27], s38 offen  lds
    v_mfma_f32_16x16x32_bf16 v[168:171], v[200:203], a[140:143], v[168:171]
    v_mfma_f32_16x16x32_bf16 v[172:175], v[204:207], a[140:143], v[172:175]
    s_add_u32 m0, s4, 11264
    ds_read_b64_tr_b16 v[188:189], v255 offset:12288
    v_mfma_f32_16x16x32_bf16 v[156:159], v[204:207], a[136:139], v[156:159]
    ds_read_b64_tr_b16 v[190:191], v255 offset:14336
    ds_read_b128 a[156:159], v2 offset:28672
    v_mfma_f32_16x16x32_bf16 v[140:143], v[204:207], a[132:135], v[140:143]
    ds_read_b128 a[160:163], v2 offset:29696
    buffer_load_dwordx4 v248, s[24:27], s39 offen  lds
    v_mfma_f32_16x16x32_bf16 v[124:127], v[204:207], a[128:131], v[124:127]
    v_add_u32 v248, 0x8000, v248
    v_and_b32 v248, 0x7ffff, v248
    v_mfma_f32_16x16x32_bf16 v[108:111], v[204:207], a[124:127], v[108:111]
    s_waitcnt lgkmcnt(4)
    v_mfma_f32_16x16x32_bf16 v[96:99], v[176:179], a[104:107], v[96:99]
    s_add_u32 m0, s4, 12288
    s_waitcnt vmcnt(12)
    ds_read_b64_tr_b16 v[192:193], v252 offset:16384
    v_mfma_f32_16x16x32_bf16 v[112:115], v[176:179], a[108:111], v[112:115]
    ds_read_b64_tr_b16 v[194:195], v252 offset:18432
    ds_read_b128 a[124:127], v2 offset:15360
    v_mfma_f32_16x16x32_bf16 v[128:131], v[176:179], a[112:115], v[128:131]
    ds_read_b128 a[128:131], v2 offset:16384
    s_waitcnt lgkmcnt(4)
    buffer_load_dwordx4 v248, s[24:27], 0 offen  lds
    v_mfma_f32_16x16x32_bf16 v[144:147], v[176:179], a[116:119], v[144:147]
    v_mfma_f32_16x16x32_bf16 v[160:163], v[176:179], a[120:123], v[160:163]
    v_mfma_f32_16x16x32_bf16 v[164:167], v[180:183], a[120:123], v[164:167]
    s_add_u32 m0, s4, 13312
    ds_read_b64_tr_b16 v[196:197], v253 offset:16384
    v_mfma_f32_16x16x32_bf16 v[148:151], v[180:183], a[116:119], v[148:151]
    ds_read_b64_tr_b16 v[198:199], v253 offset:18432
    ds_read_b128 a[132:135], v2 offset:17408
    v_mfma_f32_16x16x32_bf16 v[132:135], v[180:183], a[112:115], v[132:135]
    ds_read_b128 a[136:139], v2 offset:18432
    ds_read_b128 a[164:167], v2 offset:30720
    v_mfma_f32_16x16x32_bf16 v[116:119], v[180:183], a[108:111], v[116:119]
    buffer_load_dwordx4 v248, s[24:27], s37 offen  lds
    v_mfma_f32_16x16x32_bf16 v[100:103], v[180:183], a[104:107], v[100:103]
    v_mfma_f32_16x16x32_bf16 v[104:107], v[184:187], a[104:107], v[104:107]
    s_add_u32 m0, s4, 14336
    ds_read_b64_tr_b16 v[200:201], v254 offset:16384
    v_mfma_f32_16x16x32_bf16 v[120:123], v[184:187], a[108:111], v[120:123]
    ds_read_b64_tr_b16 v[202:203], v254 offset:18432
    ds_read_b128 a[140:143], v2 offset:19456
    v_mfma_f32_16x16x32_bf16 v[136:139], v[184:187], a[112:115], v[136:139]
    ds_read_b128 a[168:171], v2 offset:31744
    ds_read_b128 a[172:175], v2 offset:32768
    v_mfma_f32_16x16x32_bf16 v[152:155], v[184:187], a[116:119], v[152:155]
    buffer_load_dwordx4 v248, s[24:27], s38 offen  lds
    v_mfma_f32_16x16x32_bf16 v[168:171], v[184:187], a[120:123], v[168:171]
    v_mfma_f32_16x16x32_bf16 v[172:175], v[188:191], a[120:123], v[172:175]
    s_add_u32 m0, s4, 15360
    ds_read_b64_tr_b16 v[204:205], v255 offset:16384
    v_mfma_f32_16x16x32_bf16 v[156:159], v[188:191], a[116:119], v[156:159]
    ds_read_b64_tr_b16 v[206:207], v255 offset:18432
    ds_read_b128 a[176:179], v2 offset:33792
    v_mfma_f32_16x16x32_bf16 v[140:143], v[188:191], a[112:115], v[140:143]
    ds_read_b128 a[180:183], v2 offset:34816
    buffer_load_dwordx4 v248, s[24:27], s39 offen  lds
    v_mfma_f32_16x16x32_bf16 v[124:127], v[188:191], a[108:111], v[124:127]
    v_add_u32 v248, 0x8000, v248
    v_and_b32 v248, 0x7ffff, v248
    v_mfma_f32_16x16x32_bf16 v[108:111], v[188:191], a[104:107], v[108:111]
    v_cvt_pk_bf16_f32 v24, v24, v25
    v_cvt_pk_bf16_f32 v25, v26, v27
    s_waitcnt lgkmcnt(4)
    v_mfma_f32_16x16x32_bf16 v[96:99], v[192:195], a[124:127], v[96:99]
    s_waitcnt vmcnt(12)
    ds_read_b64_tr_b16 v[176:177], v252 offset:0
    ds_read_b64_tr_b16 v[178:179], v252 offset:2048
    v_mfma_f32_16x16x32_bf16 v[112:115], v[192:195], a[128:131], v[112:115]
    ds_read_b128 a[104:107], v2 offset:20480
    ds_read_b128 a[108:111], v2 offset:21504
    v_mfma_f32_16x16x32_bf16 v[128:131], v[192:195], a[132:135], v[128:131]
    s_add_u32 s7, s57, 0
    v_cvt_pk_bf16_f32 v26, v28, v29
    v_mfma_f32_16x16x32_bf16 v[144:147], v[192:195], a[136:139], v[144:147]
    v_cvt_pk_bf16_f32 v27, v30, v31
    v_mfma_f32_16x16x32_bf16 v[160:163], v[192:195], a[140:143], v[160:163]
    buffer_store_dwordx4 v[24:27], v5, s[28:31], s7 offen sc1
    v_mfma_f32_16x16x32_bf16 v[164:167], v[196:199], a[140:143], v[164:167]
    s_waitcnt vmcnt(9)
    ds_read_b64_tr_b16 v[180:181], v252 offset:4096
    ds_read_b64_tr_b16 v[182:183], v252 offset:6144
    v_mfma_f32_16x16x32_bf16 v[148:151], v[196:199], a[136:139], v[148:151]
    ds_read_b128 a[112:115], v2 offset:22528
    ds_read_b128 a[116:119], v2 offset:23552
    v_mfma_f32_16x16x32_bf16 v[132:135], v[196:199], a[132:135], v[132:135]
    ds_read_b128 a[184:187], v2 offset:35840
    s_add_u32 s7, s57, 1024
    v_mfma_f32_16x16x32_bf16 v[116:119], v[196:199], a[128:131], v[116:119]
    v_cvt_pk_bf16_f32 v40, v40, v41
    v_cvt_pk_bf16_f32 v41, v42, v43
    v_mfma_f32_16x16x32_bf16 v[100:103], v[196:199], a[124:127], v[100:103]
    v_cvt_pk_bf16_f32 v42, v44, v45
    v_cvt_pk_bf16_f32 v43, v46, v47
    v_mfma_f32_16x16x32_bf16 v[104:107], v[200:203], a[124:127], v[104:107]
    s_waitcnt vmcnt(5)
    ds_read_b64_tr_b16 v[184:185], v252 offset:8192
    ds_read_b64_tr_b16 v[186:187], v252 offset:10240
    v_mfma_f32_16x16x32_bf16 v[120:123], v[200:203], a[128:131], v[120:123]
    ds_read_b128 a[120:123], v2 offset:24576
    ds_read_b128 a[188:191], v2 offset:36864
    v_mfma_f32_16x16x32_bf16 v[136:139], v[200:203], a[132:135], v[136:139]
    ds_read_b128 a[192:195], v2 offset:37888
    buffer_store_dwordx4 v[40:43], v5, s[28:31], s7 offen sc1
    v_mfma_f32_16x16x32_bf16 v[152:155], v[200:203], a[136:139], v[152:155]
    v_mfma_f32_16x16x32_bf16 v[168:171], v[200:203], a[140:143], v[168:171]
    s_waitcnt lgkmcnt(5)
    v_mfma_f32_16x16x32_bf16 v[172:175], v[204:207], a[140:143], v[172:175]
    ds_read_b64_tr_b16 v[188:189], v253 offset:0
    ds_read_b64_tr_b16 v[190:191], v253 offset:2048
    v_mfma_f32_16x16x32_bf16 v[156:159], v[204:207], a[136:139], v[156:159]
    ds_read_b128 a[196:199], v2 offset:38912
    ds_read_b128 a[200:203], v2 offset:39936
    v_mfma_f32_16x16x32_bf16 v[140:143], v[204:207], a[132:135], v[140:143]
    s_add_u32 s7, s57, 2048
    v_cvt_pk_bf16_f32 v56, v56, v57
    v_mfma_f32_16x16x32_bf16 v[124:127], v[204:207], a[128:131], v[124:127]
    v_cvt_pk_bf16_f32 v57, v58, v59
    v_cvt_pk_bf16_f32 v58, v60, v61
    v_mfma_f32_16x16x32_bf16 v[108:111], v[204:207], a[124:127], v[108:111]
    v_cvt_pk_bf16_f32 v59, v62, v63
    buffer_store_dwordx4 v[56:59], v5, s[28:31], s7 offen sc1
    s_waitcnt lgkmcnt(4)
    v_mfma_f32_16x16x32_bf16 v[96:99], v[176:179], a[104:107], v[96:99]
    ds_read_b64_tr_b16 v[192:193], v253 offset:4096
    ds_read_b64_tr_b16 v[194:195], v253 offset:6144
    v_mfma_f32_16x16x32_bf16 v[112:115], v[176:179], a[108:111], v[112:115]
    s_and_b32 s3, s49, 3
    s_lshl_b32 s3, s3, 4
    v_mfma_f32_16x16x32_bf16 v[128:131], v[176:179], a[112:115], v[128:131]
    s_mov_b64 s[36:37], 0xffff
    s_lshl_b64 s[36:37], s[36:37], s3
    v_mfma_f32_16x16x32_bf16 v[144:147], v[176:179], a[116:119], v[144:147]
    s_cmp_lt_u32 s49, 4
    s_cselect_b64 s[40:41], s[36:37], 0
    s_cselect_b64 s[42:43], 0, s[36:37]
    s_not_b64 s[36:37], s[40:41]
    v_mfma_f32_16x16x32_bf16 v[160:163], v[176:179], a[120:123], v[160:163]
    s_not_b64 s[38:39], s[42:43]
    v_mov_b32 v222, 0x10000000
    v_mfma_f32_16x16x32_bf16 v[160:163], v[180:183], a[160:163], v[160:163]
    ds_read_b64_tr_b16 v[196:197], v253 offset:8192
    ds_read_b64_tr_b16 v[198:199], v253 offset:10240
    v_mfma_f32_16x16x32_bf16 v[144:147], v[180:183], a[156:159], v[144:147]
    s_add_u32 s7, s57, 3072
    v_cndmask_b32 v221, v219, v222, s[40:41]
    v_mfma_f32_16x16x32_bf16 v[128:131], v[180:183], a[152:155], v[128:131]
    v_cndmask_b32 v222, v219, v222, s[42:43]
    v_cvt_pk_bf16_f32 v72, v72, v73
    v_mfma_f32_16x16x32_bf16 v[112:115], v[180:183], a[148:151], v[112:115]
    v_cvt_pk_bf16_f32 v73, v74, v75
    v_cvt_pk_bf16_f32 v74, v76, v77
    v_mfma_f32_16x16x32_bf16 v[96:99], v[180:183], a[144:147], v[96:99]
    v_cvt_pk_bf16_f32 v75, v78, v79
    buffer_store_dwordx4 v[72:75], v5, s[28:31], s7 offen sc1
    v_mfma_f32_16x16x32_bf16 v[96:99], v[184:187], a[164:167], v[96:99]
    s_waitcnt vmcnt(4)
    ds_read_b64_tr_b16 v[200:201], v252 offset:12288
    ds_read_b64_tr_b16 v[202:203], v252 offset:14336
    v_mfma_f32_16x16x32_bf16 v[112:115], v[184:187], a[168:171], v[112:115]
    v_mfma_f32_16x16x32_bf16 v[128:131], v[184:187], a[172:175], v[128:131]
    v_mfma_f32_16x16x32_bf16 v[144:147], v[184:187], a[176:179], v[144:147]
    v_mfma_f32_16x16x32_bf16 v[160:163], v[184:187], a[180:183], v[160:163]
    s_waitcnt lgkmcnt(2)
    v_mfma_f32_16x16x32_bf16 v[164:167], v[188:191], a[120:123], v[164:167]
    ds_read_b64_tr_b16 v[204:205], v253 offset:12288
    ds_read_b64_tr_b16 v[206:207], v253 offset:14336
    v_mfma_f32_16x16x32_bf16 v[148:151], v[188:191], a[116:119], v[148:151]
    s_add_u32 s7, s57, 4096
    v_cvt_pk_bf16_f32 v88, v88, v89
    v_mfma_f32_16x16x32_bf16 v[132:135], v[188:191], a[112:115], v[132:135]
    v_cvt_pk_bf16_f32 v89, v90, v91
    v_cvt_pk_bf16_f32 v90, v92, v93
    v_mfma_f32_16x16x32_bf16 v[116:119], v[188:191], a[108:111], v[116:119]
    v_cvt_pk_bf16_f32 v91, v94, v95
    v_mfma_f32_16x16x32_bf16 v[100:103], v[188:191], a[104:107], v[100:103]
    buffer_store_dwordx4 v[88:91], v5, s[28:31], s7 offen sc1
    v_mfma_f32_16x16x32_bf16 v[100:103], v[192:195], a[144:147], v[100:103]
    ds_read_b64_tr_b16 v[176:177], v254 offset:0
    ds_read_b64_tr_b16 v[178:179], v254 offset:2048
    v_mfma_f32_16x16x32_bf16 v[116:119], v[192:195], a[148:151], v[116:119]
    v_mfma_f32_16x16x32_bf16 v[132:135], v[192:195], a[152:155], v[132:135]
    v_mfma_f32_16x16x32_bf16 v[148:151], v[192:195], a[156:159], v[148:151]
    v_mfma_f32_16x16x32_bf16 v[164:167], v[192:195], a[160:163], v[164:167]
    v_mfma_f32_16x16x32_bf16 v[164:167], v[196:199], a[180:183], v[164:167]
    ds_read_b64_tr_b16 v[180:181], v254 offset:4096
    ds_read_b64_tr_b16 v[182:183], v254 offset:6144
    v_mfma_f32_16x16x32_bf16 v[148:151], v[196:199], a[176:179], v[148:151]
    v_mfma_f32_16x16x32_bf16 v[132:135], v[196:199], a[172:175], v[132:135]
    v_mfma_f32_16x16x32_bf16 v[116:119], v[196:199], a[168:171], v[116:119]
    v_mfma_f32_16x16x32_bf16 v[100:103], v[196:199], a[164:167], v[100:103]
    s_waitcnt lgkmcnt(4)
    v_mfma_f32_16x16x32_bf16 v[96:99], v[200:203], a[184:187], v[96:99]
    ds_read_b64_tr_b16 v[184:185], v254 offset:8192
    ds_read_b64_tr_b16 v[186:187], v254 offset:10240
    v_mfma_f32_16x16x32_bf16 v[112:115], v[200:203], a[188:191], v[112:115]
    v_mfma_f32_16x16x32_bf16 v[128:131], v[200:203], a[192:195], v[128:131]
    v_mfma_f32_16x16x32_bf16 v[144:147], v[200:203], a[196:199], v[144:147]
    v_mfma_f32_16x16x32_bf16 v[160:163], v[200:203], a[200:203], v[160:163]
    v_mfma_f32_16x16x32_bf16 v[164:167], v[204:207], a[200:203], v[164:167]
    ds_read_b64_tr_b16 v[188:189], v254 offset:12288
    ds_read_b64_tr_b16 v[190:191], v254 offset:14336
    v_mfma_f32_16x16x32_bf16 v[148:151], v[204:207], a[196:199], v[148:151]
    v_mfma_f32_16x16x32_bf16 v[132:135], v[204:207], a[192:195], v[132:135]
    v_mfma_f32_16x16x32_bf16 v[116:119], v[204:207], a[188:191], v[116:119]
    v_mfma_f32_16x16x32_bf16 v[100:103], v[204:207], a[184:187], v[100:103]
    s_waitcnt lgkmcnt(4)
    v_mfma_f32_16x16x32_bf16 v[104:107], v[176:179], a[104:107], v[104:107]
    ds_read_b64_tr_b16 v[192:193], v255 offset:0
    ds_read_b64_tr_b16 v[194:195], v255 offset:2048
    v_mfma_f32_16x16x32_bf16 v[120:123], v[176:179], a[108:111], v[120:123]
    v_mfma_f32_16x16x32_bf16 v[136:139], v[176:179], a[112:115], v[136:139]
    v_mfma_f32_16x16x32_bf16 v[152:155], v[176:179], a[116:119], v[152:155]
    v_mfma_f32_16x16x32_bf16 v[168:171], v[176:179], a[120:123], v[168:171]
    v_mfma_f32_16x16x32_bf16 v[168:171], v[180:183], a[160:163], v[168:171]
    ds_read_b64_tr_b16 v[196:197], v255 offset:4096
    ds_read_b64_tr_b16 v[198:199], v255 offset:6144
    v_mfma_f32_16x16x32_bf16 v[152:155], v[180:183], a[156:159], v[152:155]
    s_add_u32 s7, s59, 40960
    v_cvt_pk_bf16_f32 v96, v96, v97
    v_mfma_f32_16x16x32_bf16 v[136:139], v[180:183], a[152:155], v[136:139]
    v_cvt_pk_bf16_f32 v97, v98, v99
    v_cvt_pk_bf16_f32 v98, v100, v101
    v_mfma_f32_16x16x32_bf16 v[120:123], v[180:183], a[148:151], v[120:123]
    v_cvt_pk_bf16_f32 v99, v102, v103
    v_cvt_pk_bf16_f32 v112, v112, v113
    v_mfma_f32_16x16x32_bf16 v[104:107], v[180:183], a[144:147], v[104:107]
    buffer_store_dwordx4 v[96:99], v5, s[28:31], s7 offen sc1
    v_cvt_pk_bf16_f32 v113, v114, v115
    s_waitcnt lgkmcnt(2)
    v_mfma_f32_16x16x32_bf16 v[104:107], v[184:187], a[164:167], v[104:107]
    ds_read_b64_tr_b16 v[200:201], v255 offset:8192
    ds_read_b64_tr_b16 v[202:203], v255 offset:10240
    v_mfma_f32_16x16x32_bf16 v[120:123], v[184:187], a[168:171], v[120:123]
    s_add_u32 s7, s59, 41984
    v_cvt_pk_bf16_f32 v114, v116, v117
    v_mfma_f32_16x16x32_bf16 v[136:139], v[184:187], a[172:175], v[136:139]
    v_cvt_pk_bf16_f32 v115, v118, v119
    v_cvt_pk_bf16_f32 v128, v128, v129
    v_mfma_f32_16x16x32_bf16 v[152:155], v[184:187], a[176:179], v[152:155]
    buffer_store_dwordx4 v[112:115], v5, s[28:31], s7 offen sc1
    s_add_u32 s7, s59, 43008
    v_mfma_f32_16x16x32_bf16 v[168:171], v[184:187], a[180:183], v[168:171]
    v_cvt_pk_bf16_f32 v129, v130, v131
    v_cvt_pk_bf16_f32 v130, v132, v133
    v_mfma_f32_16x16x32_bf16 v[168:171], v[188:191], a[200:203], v[168:171]
    ds_read_b64_tr_b16 v[204:205], v255 offset:12288
    ds_read_b64_tr_b16 v[206:207], v255 offset:14336
    v_mfma_f32_16x16x32_bf16 v[152:155], v[188:191], a[196:199], v[152:155]
    v_cvt_pk_bf16_f32 v131, v134, v135
    v_cvt_pk_bf16_f32 v144, v144, v145
    v_mfma_f32_16x16x32_bf16 v[136:139], v[188:191], a[192:195], v[136:139]
    buffer_store_dwordx4 v[128:131], v5, s[28:31], s7 offen sc1
    s_add_u32 s7, s59, 44032
    v_mfma_f32_16x16x32_bf16 v[120:123], v[188:191], a[188:191], v[120:123]
    v_cvt_pk_bf16_f32 v145, v146, v147
    v_cvt_pk_bf16_f32 v146, v148, v149
    v_mfma_f32_16x16x32_bf16 v[104:107], v[188:191], a[184:187], v[104:107]
    v_cvt_pk_bf16_f32 v147, v150, v151
    buffer_store_dwordx4 v[144:147], v5, s[28:31], s7 offen sc1
    v_mfma_f32_16x16x32_bf16 v[108:111], v[192:195], a[104:107], v[108:111]
    s_add_u32 s7, s59, 45056
    v_cvt_pk_bf16_f32 v160, v160, v161
    v_mfma_f32_16x16x32_bf16 v[124:127], v[192:195], a[108:111], v[124:127]
    v_cvt_pk_bf16_f32 v161, v162, v163
    v_cvt_pk_bf16_f32 v162, v164, v165
    v_mfma_f32_16x16x32_bf16 v[140:143], v[192:195], a[112:115], v[140:143]
    v_cvt_pk_bf16_f32 v163, v166, v167
    v_mfma_f32_16x16x32_bf16 v[156:159], v[192:195], a[116:119], v[156:159]
    buffer_store_dwordx4 v[160:163], v5, s[28:31], s7 offen sc1
    v_mfma_f32_16x16x32_bf16 v[172:175], v[192:195], a[120:123], v[172:175]
    s_waitcnt lgkmcnt(0)
    v_mfma_f32_16x16x32_bf16 v[172:175], v[196:199], a[160:163], v[172:175]
    v_mfma_f32_16x16x32_bf16 v[156:159], v[196:199], a[156:159], v[156:159]
    v_mfma_f32_16x16x32_bf16 v[140:143], v[196:199], a[152:155], v[140:143]
    v_mfma_f32_16x16x32_bf16 v[124:127], v[196:199], a[148:151], v[124:127]
    v_mfma_f32_16x16x32_bf16 v[108:111], v[196:199], a[144:147], v[108:111]
    v_mfma_f32_16x16x32_bf16 v[108:111], v[200:203], a[164:167], v[108:111]
    v_mfma_f32_16x16x32_bf16 v[124:127], v[200:203], a[168:171], v[124:127]
    v_mfma_f32_16x16x32_bf16 v[140:143], v[200:203], a[172:175], v[140:143]
    v_mfma_f32_16x16x32_bf16 v[156:159], v[200:203], a[176:179], v[156:159]
    v_mfma_f32_16x16x32_bf16 v[172:175], v[200:203], a[180:183], v[172:175]
    v_mfma_f32_16x16x32_bf16 v[172:175], v[204:207], a[200:203], v[172:175]
    v_mfma_f32_16x16x32_bf16 v[156:159], v[204:207], a[196:199], v[156:159]
    v_mfma_f32_16x16x32_bf16 v[140:143], v[204:207], a[192:195], v[140:143]
    v_mfma_f32_16x16x32_bf16 v[124:127], v[204:207], a[188:191], v[124:127]
    v_mfma_f32_16x16x32_bf16 v[108:111], v[204:207], a[184:187], v[108:111]
    v_cvt_pk_bf16_f32 v104, v104, v105
    v_cvt_pk_bf16_f32 v105, v106, v107
    s_add_u32 s7, s57, 40960
    s_nop 4
    v_cvt_pk_bf16_f32 v106, v108, v109
    v_cvt_pk_bf16_f32 v107, v110, v111
    buffer_store_dwordx4 v[104:107], v5, s[28:31], s7 offen sc1
    v_cvt_pk_bf16_f32 v120, v120, v121
    v_cvt_pk_bf16_f32 v121, v122, v123
    s_add_u32 s7, s57, 41984
    v_cvt_pk_bf16_f32 v122, v124, v125
    v_cvt_pk_bf16_f32 v123, v126, v127
    buffer_store_dwordx4 v[120:123], v5, s[28:31], s7 offen sc1
    v_cvt_pk_bf16_f32 v136, v136, v137
    v_cvt_pk_bf16_f32 v137, v138, v139
    s_add_u32 s7, s57, 43008
    v_cvt_pk_bf16_f32 v138, v140, v141
    v_cvt_pk_bf16_f32 v139, v142, v143
    buffer_store_dwordx4 v[136:139], v5, s[28:31], s7 offen sc1
    v_cvt_pk_bf16_f32 v152, v152, v153
    v_cvt_pk_bf16_f32 v153, v154, v155
    s_add_u32 s7, s57, 44032
    v_cvt_pk_bf16_f32 v154, v156, v157
    v_cvt_pk_bf16_f32 v155, v158, v159
    buffer_store_dwordx4 v[152:155], v5, s[28:31], s7 offen sc1
    v_cvt_pk_bf16_f32 v168, v168, v169
    v_cvt_pk_bf16_f32 v169, v170, v171
    s_add_u32 s7, s57, 45056
    v_cvt_pk_bf16_f32 v170, v172, v173
    v_cvt_pk_bf16_f32 v171, v174, v175
    buffer_store_dwordx4 v[168:171], v5, s[28:31], s7 offen sc1
    s_barrier
    v_lshlrev_b32 v3, 4, v0
    s_cmp_gt_u32 s58, 1
    s_cbranch_scc1 L_noexp
    s_cmp_eq_u32 s58, 1
    s_cbranch_scc1 L_exp1
    ds_write_b128 v3, v[16:19] offset:16384
    ds_write_b128 v3, v[32:35] offset:17408
    ds_write_b128 v3, v[48:51] offset:18432
    ds_write_b128 v3, v[64:67] offset:19456
    ds_write_b128 v3, v[80:83] offset:20480
    ds_write_b128 v3, v[96:99] offset:21504
    ds_write_b128 v3, v[112:115] offset:22528
    ds_write_b128 v3, v[128:131] offset:23552
    ds_write_b128 v3, v[144:147] offset:24576
    ds_write_b128 v3, v[160:163] offset:25600
    s_waitcnt lgkmcnt(0)
    s_branch L_noexp
L_exp1:
    ds_write_b128 v3, v[24:27] offset:16384
    ds_write_b128 v3, v[40:43] offset:17408
    ds_write_b128 v3, v[56:59] offset:18432
    ds_write_b128 v3, v[72:75] offset:19456
    ds_write_b128 v3, v[88:91] offset:20480
    ds_write_b128 v3, v[104:107] offset:21504
    ds_write_b128 v3, v[120:123] offset:22528
    ds_write_b128 v3, v[136:139] offset:23552
    ds_write_b128 v3, v[152:155] offset:24576
    ds_write_b128 v3, v[168:171] offset:25600
    s_waitcnt lgkmcnt(0)
L_noexp:
    v_and_b32 v3, 15, v0
    s_lshl_b32 s3, s47, 8
    v_lshl_add_u32 v3, v3, 4, s3
    s_barrier
    s_mov_b64 exec, s[40:41]
    ds_read_b128 v[20:23], v3 offset:16384
    ds_read_b128 v[36:39], v3 offset:17408
    ds_read_b128 v[52:55], v3 offset:18432
    ds_read_b128 v[68:71], v3 offset:19456
    ds_read_b128 v[84:87], v3 offset:20480
    ds_read_b128 v[100:103], v3 offset:21504
    ds_read_b128 v[116:119], v3 offset:22528
    ds_read_b128 v[132:135], v3 offset:23552
    ds_read_b128 v[148:151], v3 offset:24576
    ds_read_b128 v[164:167], v3 offset:25600
    s_mov_b64 exec, s[42:43]
    ds_read_b128 v[28:31], v3 offset:16384
    ds_read_b128 v[44:47], v3 offset:17408
    ds_read_b128 v[60:63], v3 offset:18432
    ds_read_b128 v[76:79], v3 offset:19456
    ds_read_b128 v[92:95], v3 offset:20480
    ds_read_b128 v[108:111], v3 offset:21504
    ds_read_b128 v[124:127], v3 offset:22528
    ds_read_b128 v[140:143], v3 offset:23552
    ds_read_b128 v[156:159], v3 offset:24576
    ds_read_b128 v[172:175], v3 offset:25600
    s_mov_b64 exec, -1
    s_mov_b64 exec, 1
    s_waitcnt vmcnt(5)
    global_store_dword v216, v217, s[96:97] offset:128 sc1
    s_mov_b64 exec, -1
    s_mov_b64 exec, 2
    s_waitcnt vmcnt(1)
    global_store_dword v216, v217, s[96:97] offset:128 sc1
    s_mov_b64 exec, -1
    s_mov_b32 s7, 0
L_pollB:
    global_load_dword v224, v218, s[96:97] offset:128 sc1
    s_add_u32 s7, s7, 1
    s_cmp_gt_u32 s7, 0x20000
    s_cbranch_scc1 L_doneB
    s_waitcnt vmcnt(0)
    v_cmp_ne_u32 vcc, 1, v224
    s_nop 3
    s_cbranch_vccz L_doneB
    s_branch L_pollB
L_doneB:
    s_mov_b64 exec, s[36:37]
    s_mov_b32 s5, 0
    s_waitcnt lgkmcnt(0)
    buffer_load_dwordx4 v[20:23], v219, s[28:31], s5 offen sc1
    s_mov_b32 s5, 40960
    buffer_load_dwordx4 v[100:103], v219, s[28:31], s5 offen sc1
    s_mov_b32 s5, 1024
    buffer_load_dwordx4 v[36:39], v219, s[28:31], s5 offen sc1
    s_mov_b32 s5, 41984
    buffer_load_dwordx4 v[116:119], v219, s[28:31], s5 offen sc1
    s_mov_b32 s5, 2048
    buffer_load_dwordx4 v[52:55], v219, s[28:31], s5 offen sc1
    s_mov_b32 s5, 43008
    buffer_load_dwordx4 v[132:135], v219, s[28:31], s5 offen sc1
    s_mov_b32 s5, 3072
    buffer_load_dwordx4 v[68:71], v219, s[28:31], s5 offen sc1
    s_mov_b32 s5, 44032
    buffer_load_dwordx4 v[148:151], v219, s[28:31], s5 offen sc1
    s_mov_b32 s5, 4096
    buffer_load_dwordx4 v[84:87], v219, s[28:31], s5 offen sc1
    s_mov_b32 s5, 45056
    buffer_load_dwordx4 v[164:167], v219, s[28:31], s5 offen sc1
    s_mov_b64 exec, s[38:39]
    s_mov_b32 s5, 20480
    buffer_load_dwordx4 v[28:31], v219, s[28:31], s5 offen sc1
    s_mov_b32 s5, 61440
    buffer_load_dwordx4 v[108:111], v219, s[28:31], s5 offen sc1
    s_mov_b32 s5, 21504
    buffer_load_dwordx4 v[44:47], v219, s[28:31], s5 offen sc1
    s_mov_b32 s5, 62464
    buffer_load_dwordx4 v[124:127], v219, s[28:31], s5 offen sc1
    s_mov_b32 s5, 22528
    buffer_load_dwordx4 v[60:63], v219, s[28:31], s5 offen sc1
    s_mov_b32 s5, 63488
    buffer_load_dwordx4 v[140:143], v219, s[28:31], s5 offen sc1
    s_mov_b32 s5, 23552
    buffer_load_dwordx4 v[76:79], v219, s[28:31], s5 offen sc1
    s_mov_b32 s5, 64512
    buffer_load_dwordx4 v[156:159], v219, s[28:31], s5 offen sc1
    s_mov_b32 s5, 24576
    buffer_load_dwordx4 v[92:95], v219, s[28:31], s5 offen sc1
    s_mov_b32 s5, 65536
    buffer_load_dwordx4 v[172:175], v219, s[28:31], s5 offen sc1
    s_mov_b64 exec, -1
    s_waitcnt vmcnt(19)
    v_mfma_f32_16x16x32_bf16 v[176:179], v[228:231], v[20:23], 0
    s_waitcnt vmcnt(9)
    v_mfma_f32_16x16x32_bf16 v[176:179], v[228:231], v[28:31], v[176:179]
    v_mfma_f32_16x16x32_bf16 v[176:179], v[232:235], v[100:103], v[176:179]
    s_waitcnt vmcnt(8)
    v_mfma_f32_16x16x32_bf16 v[176:179], v[232:235], v[108:111], v[176:179]
    v_mfma_f32_16x16x32_bf16 v[180:183], v[228:231], v[36:39], 0
    s_waitcnt vmcnt(7)
    v_mfma_f32_16x16x32_bf16 v[180:183], v[228:231], v[44:47], v[180:183]
    v_mfma_f32_16x16x32_bf16 v[180:183], v[232:235], v[116:119], v[180:183]
    s_waitcnt vmcnt(6)
    v_mfma_f32_16x16x32_bf16 v[180:183], v[232:235], v[124:127], v[180:183]
    s_nop 1
    v_cvt_pk_bf16_f32 v196, v176, v177
    v_cvt_pk_bf16_f32 v197, v178, v179
    ds_write_b64 v6, v[196:197] offset:0
    v_mfma_f32_16x16x32_bf16 v[184:187], v[228:231], v[52:55], 0
    s_waitcnt vmcnt(5)
    v_mfma_f32_16x16x32_bf16 v[184:187], v[228:231], v[60:63], v[184:187]
    v_mfma_f32_16x16x32_bf16 v[184:187], v[232:235], v[132:135], v[184:187]
    s_waitcnt vmcnt(4)
    v_mfma_f32_16x16x32_bf16 v[184:187], v[232:235], v[140:143], v[184:187]
    v_cvt_pk_bf16_f32 v198, v180, v181
    v_cvt_pk_bf16_f32 v199, v182, v183
    ds_write_b64 v6, v[198:199] offset:2304
    v_mfma_f32_16x16x32_bf16 v[188:191], v[228:231], v[68:71], 0
    s_waitcnt vmcnt(3)
    v_mfma_f32_16x16x32_bf16 v[188:191], v[228:231], v[76:79], v[188:191]
    v_mfma_f32_16x16x32_bf16 v[188:191], v[232:235], v[148:151], v[188:191]
    s_waitcnt vmcnt(2)
    v_mfma_f32_16x16x32_bf16 v[188:191], v[232:235], v[156:159], v[188:191]
    v_cvt_pk_bf16_f32 v196, v184, v185
    v_cvt_pk_bf16_f32 v197, v186, v187
    ds_write_b64 v6, v[196:197] offset:4608
    v_mfma_f32_16x16x32_bf16 v[192:195], v[228:231], v[84:87], 0
    s_waitcnt vmcnt(1)
    v_mfma_f32_16x16x32_bf16 v[192:195], v[228:231], v[92:95], v[192:195]
    v_mfma_f32_16x16x32_bf16 v[192:195], v[232:235], v[164:167], v[192:195]
    s_waitcnt vmcnt(0)
    v_mfma_f32_16x16x32_bf16 v[192:195], v[232:235], v[172:175], v[192:195]
    v_cvt_pk_bf16_f32 v198, v188, v189
    v_cvt_pk_bf16_f32 v199, v190, v191
    ds_write_b64 v6, v[198:199] offset:6912
    s_nop 4
    v_cvt_pk_bf16_f32 v196, v192, v193
    v_cvt_pk_bf16_f32 v197, v194, v195
    ds_write_b64 v6, v[196:197] offset:9216
    s_waitcnt lgkmcnt(0)
    s_barrier
    ds_read_b128 v[16:19], v7 offset:0
    ds_read_b128 v[20:23], v7 offset:1152
    ds_read_b128 v[24:27], v7 offset:2304
    s_mov_b32 s3, 0
    s_waitcnt lgkmcnt(2)
    buffer_store_dwordx4 v[16:19], v4, s[32:35], s3 offen sc1
    s_mov_b32 s58, 32768
    s_mov_b32 s3, 16384
    s_waitcnt lgkmcnt(1)
    buffer_store_dwordx4 v[20:23], v4, s[32:35], s3 offen sc1
    s_mov_b64 exec, 0xffffffff
    s_waitcnt lgkmcnt(0)
    buffer_store_dwordx4 v[24:27], v4, s[32:35], s58 offen sc1
L_end:
    s_endpgm
.section .rodata,"a"
.p2align 6
.amdhsa_kernel concat_heads__mha_block_cached__mha_block_cached__near_ridge_kernel
  .amdhsa_next_free_vgpr 512
  .amdhsa_next_free_sgpr 102
  .amdhsa_accum_offset 256
  .amdhsa_float_denorm_mode_32 3
  .amdhsa_group_segment_fixed_size 0
  .amdhsa_kernarg_size 104
  .amdhsa_user_sgpr_count 2
  .amdhsa_user_sgpr_kernarg_segment_ptr 1
  .amdhsa_system_sgpr_workgroup_id_x 1
.end_amdhsa_kernel
```
